```python
import torch

def _softmax(x, axis=-1):
    return torch.softmax(x, dim=axis)
def _gelu(x):
    return torch.nn.functional.gelu(x, approximate="tanh")
def _silu(x):
    return torch.nn.functional.silu(x)
def _sigmoid(x):
    return torch.sigmoid(x)
def _layernorm(x, axis=-1, eps=1e-5):
    m = x.mean(dim=axis, keepdim=True)
    v = x.var(dim=axis, keepdim=True, unbiased=False)
    return (x - m) / torch.sqrt(v + eps)
def _scatter_add(tgt, idx, src, axis=0):
    return tgt.clone().index_add_(axis, idx, src)
def _segment_sum(src, seg, n):
    out = torch.zeros((n,) + src.shape[1:], dtype=src.dtype)
    return out.index_add_(0, seg, src)
def _pad(x, pw):
    flat = tuple(v for pair in reversed(pw) for v in pair)
    return torch.nn.functional.pad(x, flat)

kernel_name = 'standalone__batchnorm__sampling'

def setup_inputs():

    _w = (lambda a: (lambda t: t.to(torch.bfloat16) if t.is_floating_point() else t)(torch.as_tensor(a)))
    B, S, C = 1024, 16, 576
    K = 3
    return {
        "x": _w((lambda *s: torch.randn(*s, dtype=torch.bfloat16) * 0.05)(B, S, C)),
        "w": _w((lambda *s: torch.randn(*s, dtype=torch.bfloat16) * 0.05)(K, C, C) * (1.0 / (K * C) ** 0.5)),
        "mean": _w((lambda *s: torch.randn(*s, dtype=torch.bfloat16) * 0.05)(C) * 0.1),
        "var": _w(torch.abs((lambda *s: torch.randn(*s, dtype=torch.bfloat16) * 0.05)(C)) + 0.5),
        "g": _w((lambda *s: torch.randn(*s, dtype=torch.bfloat16) * 0.05)(C) + 1.0),
        "b": _w((lambda *s: torch.randn(*s, dtype=torch.bfloat16) * 0.05)(C) * 0.1),
    }

def reference(x, w, mean, var, g, b):
    K = 3
    P = K // 2
    S = x.shape[1]
    xp = _pad(x, ((0, 0), (P, P), (0, 0)))
    y = sum(torch.einsum('bsc,cd->bsd', xp[:, k:k + S, :], w[k]) for k in range(K))
    inv_std = 1.0 / torch.sqrt(var + 1e-5)
    y = (y - mean) * (g * inv_std) + b
    return _silu(y)
```

```asm
; @launch grid=(256,1,1) block=(512,1,1) lds=163200
.amdgcn_target "amdgcn-amd-amdhsa--gfx950"
.text
.globl standalone__batchnorm__sampling_kernel
.p2align 12
.p2align 8
.type standalone__batchnorm__sampling_kernel,@function
standalone__batchnorm__sampling_kernel:
    s_load_dwordx8 s[4:11], s[0:1], 0
    s_load_dwordx4 s[12:15], s[0:1], 32
    s_load_dwordx2 s[16:17], s[0:1], 48
    v_lshrrev_b32 v1, 6, v0
    v_and_b32 v252, 63, v0
    s_cmp_ge_u32 s2, 256
    s_cbranch_scc1 L_end
    v_readfirstlane_b32 s48, v1
    s_and_b32 s49, s2, 7
    s_lshr_b32 s53, s2, 5
    s_lshl3_add_u32 s49, s49, s53
    s_bfe_u32 s50, s2, 0x20003
    s_and_b32 s57, s50, 1
    s_mulk_i32 s50, 288
    s_lshl_b32 s53, s57, 5
    s_sub_u32 s50, s50, s53
    s_and_b32 s51, s48, 3
    s_lshl2_add_u32 s56, s49, s51
    s_mul_i32 s56, s56, 73728
    s_mul_i32 s52, s51, 8704
    s_mov_b32 s22, 18874368
    s_mov_b32 s23, 0x20000
    v_lshrrev_b32 v148, 3, v252
    v_and_b32 v149, 7, v252
    v_and_b32 v150, 6, v148
    v_xor_b32 v150, v149, v150
    v_mul_u32_u24 v253, 1152, v148
    v_lshl_add_u32 v253, v150, 4, v253
    s_cmp_ge_u32 s48, 4
    s_cbranch_scc1 L_loader
    s_setprio 2
    s_mov_b64 exec, 0
    s_cmp_eq_u32 s51, 0
    s_cbranch_scc1 N_4
    s_cmp_eq_u32 s51, 1
    s_cbranch_scc1 N_3
    s_cmp_eq_u32 s51, 2
    s_cbranch_scc1 N_2
    s_branch N_1
L_t0ret:
    s_mov_b64 exec, -1
    s_mul_i32 s60, s57, 36864
    s_xor_b32 s62, s60, 36864
    s_add_u32 s53, s56, s62
    s_add_u32 m0, s52, 4480
    s_waitcnt lgkmcnt(0)
    s_mov_b64 s[20:21], s[4:5]
    buffer_load_dwordx4 v253, s[20:23], s53 offen lds
    s_addk_i32 m0, 1024
    s_addk_i32 s53, 9216
    buffer_load_dwordx4 v253, s[20:23], s53 offen lds
    s_addk_i32 m0, 1152
    s_addk_i32 s53, 9216
    buffer_load_dwordx4 v253, s[20:23], s53 offen lds
    s_addk_i32 m0, 1024
    s_addk_i32 s53, 9216
    buffer_load_dwordx4 v253, s[20:23], s53 offen lds
    s_addk_i32 m0, -7552
    s_add_u32 s61, s56, s60
    buffer_load_dwordx4 v253, s[20:23], s61 offen lds
    s_addk_i32 m0, 1024
    s_addk_i32 s61, 9216
    buffer_load_dwordx4 v253, s[20:23], s61 offen lds
    s_addk_i32 m0, 1152
    s_addk_i32 s61, 9216
    buffer_load_dwordx4 v253, s[20:23], s61 offen lds
    s_addk_i32 m0, 1024
    s_addk_i32 s61, 9216
    buffer_load_dwordx4 v253, s[20:23], s61 offen lds
    s_branch L_csetup
L_loader:
    s_setprio 3
    s_mov_b32 s26, 1990656
    s_mov_b32 s27, 0x20000
    s_movk_i32 s60, 0x34
    s_movk_i32 s61, 1152
    s_lshl_b32 s62, s57, 2
    s_lshl_b32 s53, s51, 6
    v_add_u32 v1, s53, v252
    v_mul_u32_u24 v3, 3277, v1
    v_lshrrev_b32 v3, 16, v3
    v_mul_u32_u24 v4, 20, v3
    v_sub_u32 v4, v1, v4
    v_lshrrev_b32 v5, 1, v3
    v_and_b32 v2, 2, v5
    v_xor_b32 v4, v2, v4
    v_add_u32 v4, s62, v4
    v_subrev_u32 v2, 20, v4
    v_min_u32 v4, v4, v2
    v_and_b32 v5, 6, v5
    v_bfe_i32 v5, s60, v5, 2
    v_lshl_add_u32 v3, v5, 2, v3
    v_lshlrev_b32 v4, 4, v4
    v_mad_u32_u24 v10, v3, s61, v4
    v_add_u32 v1, 256, v252
    v_mul_u32_u24 v3, 3277, v1
    v_lshrrev_b32 v3, 16, v3
    v_mul_u32_u24 v4, 20, v3
    v_sub_u32 v4, v1, v4
    v_lshrrev_b32 v5, 1, v3
    v_and_b32 v2, 2, v5
    v_xor_b32 v4, v2, v4
    v_add_u32 v4, s62, v4
    v_subrev_u32 v2, 20, v4
    v_min_u32 v4, v4, v2
    v_and_b32 v5, 6, v5
    v_bfe_i32 v5, s60, v5, 2
    v_lshl_add_u32 v3, v5, 2, v3
    v_lshlrev_b32 v4, 4, v4
    v_mad_u32_u24 v11, v3, s61, v4
    s_lshl_b32 s62, s51, 10
    s_add_u32 s38, s62, 69760
    s_add_u32 s39, s38, 92160
    s_mov_b32 s36, s38
    s_mov_b32 s37, s50
    s_lshl_b32 s40, s51, 12
    s_addk_i32 s40, 4096
    s_and_b32 s53, s51, 1
    s_mul_i32 s43, s53, 18432
    s_lshr_b32 s41, s51, 1
    s_mul_i32 s41, s41, 663552
    s_add_u32 s41, s41, s43
    s_add_u32 s43, s43, 1327104
    s_mulk_i32 s53, 5120
    s_addk_i32 s53, 24576
    s_sub_u32 s42, s53, s62
    s_mov_b32 s44, -2
    s_cmp_lt_u32 s51, 2
    s_cselect_b64 s[46:47], -1, 1
    s_waitcnt lgkmcnt(0)
    s_mov_b64 s[24:25], s[6:7]
    s_mov_b64 s[20:21], s[4:5]
L_lw:
    s_mov_b32 m0, s36
    s_mov_b32 s53, s37
    buffer_load_dwordx4 v10, s[24:27], s53 offen lds
    s_addk_i32 m0, 5120
    s_addk_i32 s53, 18432
    buffer_load_dwordx4 v10, s[24:27], s53 offen lds
    s_addk_i32 m0, 5120
    s_add_u32 s53, s53, 645120
    buffer_load_dwordx4 v10, s[24:27], s53 offen lds
    s_addk_i32 m0, 5120
    s_addk_i32 s53, 18432
    buffer_load_dwordx4 v10, s[24:27], s53 offen lds
    s_addk_i32 m0, 5120
    s_add_u32 s53, s53, 645120
    buffer_load_dwordx4 v10, s[24:27], s53 offen lds
    s_addk_i32 m0, 5120
    s_addk_i32 s53, 18432
    buffer_load_dwordx4 v10, s[24:27], s53 offen lds
    s_add_u32 m0, s36, s40
    s_add_u32 s53, s37, s41
    buffer_load_dwordx4 v11, s[24:27], s53 offen lds
    s_mov_b64 exec, s[46:47]
    s_add_u32 m0, s36, s42
    s_add_u32 s53, s37, s43
    buffer_load_dwordx4 v11, s[24:27], s53 offen lds
    s_mov_b64 exec, -1
    s_setprio 0
    s_addk_i32 s36, 30720
    s_cmp_eq_u32 s36, s39
    s_cselect_b32 s36, s38, s36
    s_add_u32 s37, s37, 36864
    s_add_i32 s44, s44, 1
    s_cmp_lt_i32 s44, 0
    s_cbranch_scc1 L_lw
    s_bitcmp1_b32 0x15554, s44
    s_cbranch_scc1 L_ltouch1
    s_bitcmp1_b32 s44, 0
    s_cbranch_scc1 L_lw12
L_lwait:
    s_waitcnt vmcnt(8)
L_lw12:
    s_waitcnt vmcnt(12)
    s_barrier
    s_cmp_eq_u32 s44, 16
    s_cbranch_scc1 L_ltail
    s_and_b32 s60, s44, 1
    s_lshr_b32 s61, s44, 1
    s_add_u32 s61, s61, 1
    s_mul_i32 s62, s60, 4352
    s_add_u32 s62, s62, s52
    s_addk_i32 s62, 128
    s_bitcmp1_b32 s61, 0
    s_cselect_b32 s63, 34816, 0
    s_add_u32 m0, s62, s63
    s_xor_b32 s60, s60, s57
    s_mul_i32 s60, s60, 36864
    s_lshl_b32 s61, s61, 7
    s_add_u32 s60, s60, s61
    s_add_u32 s60, s60, s56
    buffer_load_dwordx4 v253, s[20:23], s60 offen lds
    s_addk_i32 m0, 1024
    s_addk_i32 s60, 9216
    buffer_load_dwordx4 v253, s[20:23], s60 offen lds
    s_addk_i32 m0, 1152
    s_addk_i32 s60, 9216
    buffer_load_dwordx4 v253, s[20:23], s60 offen lds
    s_addk_i32 m0, 1024
    s_addk_i32 s60, 9216
    buffer_load_dwordx4 v253, s[20:23], s60 offen lds
    s_branch L_lw
    s_endpgm
    s_endpgm
    s_endpgm
    s_endpgm
    s_endpgm
    s_endpgm
    s_endpgm
    s_endpgm
    s_endpgm
    s_endpgm
    s_endpgm
    s_endpgm
    s_endpgm
    s_endpgm
    s_endpgm
    s_endpgm
    s_endpgm
    s_endpgm
    s_endpgm
    s_endpgm
    s_endpgm
    s_endpgm
    s_endpgm
    s_endpgm
    s_endpgm
    s_endpgm
    s_endpgm
    s_endpgm
    s_endpgm
    s_endpgm
    s_endpgm
    s_endpgm
    s_endpgm
    s_endpgm
    s_endpgm
    s_endpgm
    s_endpgm
    s_endpgm
    s_endpgm
    s_endpgm
    s_endpgm
    s_endpgm
    s_endpgm
    s_endpgm
    s_endpgm
    s_endpgm
    s_endpgm
    s_endpgm
    s_endpgm
    s_endpgm
    s_endpgm
    s_endpgm
    s_endpgm
    s_endpgm
    s_endpgm
    s_endpgm
    s_endpgm
    s_endpgm
    s_endpgm
    s_endpgm
    s_endpgm
    s_endpgm
    s_endpgm
    s_endpgm
    s_endpgm
    s_endpgm
    s_endpgm
    s_endpgm
    s_endpgm
    s_endpgm
    s_endpgm
    s_endpgm
    s_endpgm
    s_endpgm
    s_endpgm
    s_endpgm
    s_endpgm
    s_endpgm
    s_endpgm
    s_endpgm
    s_endpgm
L_ltouch1:
    s_mov_b64 exec, 0
    s_cmp_eq_u32 s44, 4
    s_cbranch_scc1 N_11
    s_cmp_eq_u32 s44, 6
    s_cbranch_scc1 N_10
    s_cmp_eq_u32 s44, 8
    s_cbranch_scc1 N_9
    s_cmp_eq_u32 s44, 10
    s_cbranch_scc1 N_8
    s_cmp_eq_u32 s44, 12
    s_cbranch_scc1 N_7
    s_cmp_eq_u32 s44, 14
    s_cbranch_scc1 N_6
    s_cmp_eq_u32 s44, 16
    s_cbranch_scc1 N_5
L_tret:
    s_mov_b64 exec, -1
    s_cmp_lg_u32 s44, 2
    s_cbranch_scc1 L_lwait
    s_lshl_b32 s53, s51, 6
    v_add_u32 v60, s53, v252
    s_lshl_b32 s53, s57, 5
    v_add_u32 v61, s53, v60
    v_subrev_u32 v62, 160, v61
    v_min_u32 v61, v61, v62
    v_lshlrev_b32 v61, 1, v61
    s_mov_b32 s28, s8
    s_and_b32 s29, s9, 0xffff
    s_movk_i32 s30, 1152
    s_mov_b32 s31, 0x20000
    buffer_load_ushort v64, v61, s[28:31], s50 offen
    s_mov_b32 s32, s10
    s_and_b32 s33, s11, 0xffff
    s_movk_i32 s34, 1152
    s_mov_b32 s35, 0x20000
    buffer_load_ushort v65, v61, s[32:35], s50 offen
    s_mov_b32 s64, s12
    s_and_b32 s65, s13, 0xffff
    s_movk_i32 s66, 1152
    s_mov_b32 s67, 0x20000
    buffer_load_ushort v66, v61, s[64:67], s50 offen
    s_mov_b32 s96, s14
    s_and_b32 s97, s15, 0xffff
    s_movk_i32 s98, 1152
    s_mov_b32 s99, 0x20000
    buffer_load_ushort v67, v61, s[96:99], s50 offen
    s_branch L_lwait
L_ltail:
    v_lshlrev_b32 v64, 16, v64
    v_lshlrev_b32 v65, 16, v65
    v_lshlrev_b32 v66, 16, v66
    v_lshlrev_b32 v67, 16, v67
    v_add_f32 v65, 0x3727c5ac, v65
    v_cvt_pk_bf16_f32 v65, v65, v65
    v_lshlrev_b32 v65, 16, v65
    v_sqrt_f32 v65, v65
    v_lshrrev_b32 v61, 4, v60
    v_cvt_pk_bf16_f32 v65, v65, v65
    v_lshlrev_b32 v65, 16, v65
    v_rcp_f32 v65, v65
    v_lshlrev_b32 v61, 7, v61
    v_cvt_pk_bf16_f32 v65, v65, v65
    v_lshlrev_b32 v65, 16, v65
    v_mul_f32 v65, v66, v65
    v_cvt_pk_bf16_f32 v65, v65, v65
    v_lshlrev_b32 v65, 16, v65
    v_fma_f32 v67, -v64, v65, v67
    v_mul_f32 v65, 0x3fb8aa3b, v65
    v_mul_f32 v67, 0x3fb8aa3b, v67
    v_and_b32 v62, 15, v60
    v_lshl_add_u32 v61, v62, 2, v61
    v_add_u32 v61, 161920, v61
    v_cmp_gt_u32 vcc, 160, v60
    s_and_saveexec_b64 s[46:47], vcc
    ds_write_b32 v61, v65
    ds_write_b32 v61, v67 offset:64
    s_mov_b64 exec, s[46:47]
    s_waitcnt vmcnt(0) lgkmcnt(0)
    s_barrier
L_end:
    s_endpgm
    s_endpgm
    s_endpgm
    s_endpgm
    s_endpgm
    s_endpgm
    s_endpgm
    s_endpgm
    s_endpgm
    s_endpgm
    s_endpgm
    s_endpgm
    s_endpgm
    s_endpgm
    s_endpgm
    s_endpgm
    s_endpgm
    s_endpgm
    s_endpgm
    s_endpgm
    s_endpgm
    s_endpgm
    s_endpgm
    s_endpgm
    s_endpgm
    s_endpgm
    s_endpgm
    s_endpgm
    s_endpgm
    s_endpgm
    s_endpgm
    s_endpgm
    s_endpgm
    s_endpgm
    s_endpgm
    s_endpgm
    s_endpgm
    s_endpgm
    s_endpgm
    s_endpgm
    s_endpgm
    s_endpgm
    s_endpgm
    s_endpgm
    s_endpgm
    s_endpgm
    s_endpgm
    s_endpgm
    s_endpgm
    s_endpgm
    s_endpgm
    s_endpgm
    s_endpgm
    s_endpgm
    s_endpgm
    s_endpgm
    s_endpgm
    s_endpgm
    s_endpgm
    s_endpgm
    s_endpgm
    s_endpgm
    s_endpgm
    s_endpgm
    s_endpgm
    s_endpgm
    s_endpgm
    s_endpgm
    s_endpgm
    s_endpgm
    s_endpgm
    s_endpgm
    s_endpgm
    s_endpgm
    s_endpgm
    s_endpgm
    s_endpgm
    s_endpgm
    s_endpgm
    s_endpgm
    s_endpgm
    s_endpgm
    s_endpgm
    s_endpgm
    s_endpgm
    s_endpgm
    s_endpgm
    s_endpgm
    s_endpgm
    s_endpgm
    s_endpgm
    s_endpgm
    s_endpgm
    s_endpgm
    s_endpgm
    s_endpgm
    s_endpgm
    s_endpgm
    s_endpgm
    s_endpgm
    s_endpgm
    s_endpgm
    s_endpgm
    s_endpgm
    s_endpgm
    s_endpgm
    s_endpgm
    s_endpgm
    s_endpgm
    s_endpgm
    s_endpgm
    s_endpgm
    s_endpgm
    s_endpgm
    s_endpgm
    s_endpgm
    s_endpgm
    s_endpgm
    s_endpgm
    s_endpgm
    s_endpgm
    s_endpgm
    s_endpgm
    s_endpgm
    s_endpgm
    s_endpgm
    s_endpgm
    s_endpgm
    s_endpgm
    s_endpgm
    s_endpgm
    s_endpgm
    s_endpgm
    s_endpgm
    s_endpgm
    s_endpgm
    s_endpgm
    s_endpgm
    s_endpgm
    s_endpgm
    s_endpgm
    s_endpgm
    s_endpgm
    s_endpgm
    s_endpgm
    s_endpgm
    s_endpgm
    s_endpgm
    s_endpgm
    s_endpgm
    s_endpgm
    s_endpgm
    s_endpgm
    s_endpgm
    s_endpgm
    s_endpgm
    s_endpgm
    s_endpgm
    s_endpgm
    s_endpgm
    s_endpgm
    s_endpgm
    s_endpgm
    s_endpgm
    s_endpgm
    s_endpgm
    s_endpgm
    s_endpgm
    s_endpgm
    s_endpgm
    s_endpgm
    s_endpgm
    s_endpgm
    s_endpgm
    s_endpgm
    s_endpgm
    s_endpgm
    s_endpgm
    s_endpgm
    s_endpgm
    s_endpgm
    s_endpgm
    s_endpgm
    s_endpgm
    s_endpgm
    s_endpgm
    s_endpgm
    s_endpgm
    s_endpgm
    s_endpgm
    s_endpgm
    s_endpgm
    s_endpgm
    s_endpgm
    s_endpgm
    s_endpgm
    s_endpgm
    s_endpgm
    s_endpgm
    s_endpgm
    s_endpgm
    s_endpgm
    s_endpgm
    s_endpgm
    s_endpgm
    s_endpgm
    s_endpgm
    s_endpgm
    s_endpgm
    s_endpgm
    s_endpgm
    s_endpgm
    s_endpgm
    s_endpgm
    s_endpgm
    s_endpgm
    s_endpgm
    s_endpgm
    s_endpgm
    s_endpgm
    s_endpgm
    s_endpgm
    s_endpgm
    s_endpgm
    s_endpgm
    s_endpgm
    s_endpgm
    s_endpgm
    s_endpgm
    s_endpgm
    s_endpgm
    s_endpgm
    s_endpgm
    s_endpgm
    s_endpgm
    s_endpgm
    s_endpgm
    s_endpgm
    s_endpgm
    s_endpgm
    s_endpgm
    s_endpgm
    s_endpgm
    s_endpgm
    s_endpgm
    s_endpgm
    s_endpgm
    s_endpgm
    s_endpgm
    s_endpgm
    s_endpgm
    s_endpgm
    s_endpgm
    s_endpgm
    s_endpgm
    s_endpgm
    s_endpgm
    s_endpgm
    s_endpgm
    s_endpgm
    s_endpgm
    s_endpgm
    s_endpgm
    s_endpgm
    s_endpgm
    s_endpgm
    s_endpgm
    s_endpgm
    s_endpgm
    s_endpgm
    s_endpgm
    s_endpgm
    s_endpgm
    s_endpgm
    s_endpgm
    s_endpgm
    s_endpgm
    s_endpgm
    s_endpgm
    s_endpgm
    s_endpgm
    s_endpgm
    s_endpgm
    s_endpgm
    s_endpgm
    s_endpgm
    s_endpgm
    s_endpgm
    s_endpgm
    s_endpgm
    s_endpgm
    s_endpgm
    s_endpgm
    s_endpgm
    s_endpgm
    s_endpgm
    s_endpgm
    s_endpgm
    s_endpgm
    s_endpgm
    s_endpgm
    s_endpgm
    s_endpgm
    s_endpgm
    s_endpgm
    s_endpgm
    s_endpgm
    s_endpgm
    s_endpgm
    s_endpgm
    s_endpgm
    s_endpgm
    s_endpgm
    s_endpgm
    s_endpgm
    s_endpgm
    s_endpgm
    s_endpgm
    s_endpgm
    s_endpgm
    s_endpgm
    s_endpgm
    s_endpgm
    s_endpgm
    s_endpgm
    s_endpgm
    s_endpgm
    s_endpgm
    s_endpgm
    s_endpgm
    s_endpgm
    s_endpgm
    s_endpgm
    s_endpgm
    s_endpgm
    s_endpgm
    s_endpgm
    s_endpgm
    s_endpgm
    s_endpgm
    s_endpgm
    s_endpgm
    s_endpgm
    s_endpgm
    s_endpgm
    s_endpgm
    s_endpgm
    s_endpgm
    s_endpgm
    s_endpgm
    s_endpgm
    s_endpgm
    s_endpgm
    s_endpgm
    s_endpgm
    s_endpgm
    s_endpgm
    s_endpgm
    s_endpgm
    s_endpgm
    s_endpgm
    s_endpgm
    s_endpgm
    s_endpgm
    s_endpgm
    s_endpgm
    s_endpgm
    s_endpgm
    s_endpgm
    s_endpgm
    s_endpgm
    s_endpgm
    s_endpgm
    s_endpgm
    s_endpgm
    s_endpgm
    s_endpgm
    s_endpgm
    s_endpgm
    s_endpgm
    s_endpgm
    s_endpgm
    s_endpgm
    s_endpgm
    s_endpgm
    s_endpgm
    s_endpgm
    s_endpgm
    s_endpgm
    s_endpgm
    s_endpgm
    s_endpgm
    s_endpgm
    s_endpgm
    s_endpgm
    s_endpgm
    s_endpgm
    s_endpgm
    s_endpgm
    s_endpgm
    s_endpgm
    s_endpgm
    s_endpgm
    s_endpgm
    s_endpgm
    s_endpgm
    s_endpgm
    s_endpgm
    s_endpgm
    s_endpgm
    s_endpgm
    s_endpgm
    s_endpgm
    s_endpgm
    s_endpgm
    s_endpgm
    s_endpgm
    s_endpgm
    s_endpgm
    s_endpgm
    s_endpgm
    s_endpgm
    s_endpgm
    s_endpgm
    s_endpgm
    s_endpgm
    s_endpgm
    s_endpgm
    s_endpgm
    s_endpgm
    s_endpgm
    s_endpgm
    s_endpgm
    s_endpgm
    s_endpgm
    s_endpgm
    s_endpgm
    s_endpgm
    s_endpgm
    s_endpgm
    s_endpgm
    s_endpgm
    s_endpgm
    s_endpgm
    s_endpgm
    s_endpgm
    s_endpgm
    s_endpgm
    s_endpgm
    s_endpgm
    s_endpgm
    s_endpgm
    s_endpgm
    s_endpgm
    s_endpgm
    s_endpgm
    s_endpgm
    s_endpgm
    s_endpgm
    s_endpgm
    s_endpgm
    s_endpgm
    s_endpgm
    s_endpgm
    s_endpgm
    s_endpgm
    s_endpgm
    s_endpgm
    s_endpgm
    s_endpgm
    s_endpgm
    s_endpgm
    s_endpgm
    s_endpgm
    s_endpgm
    s_endpgm
    s_endpgm
    s_endpgm
    s_endpgm
    s_endpgm
    s_endpgm
    s_endpgm
    s_endpgm
    s_endpgm
    s_endpgm
    s_endpgm
    s_endpgm
    s_endpgm
    s_endpgm
    s_endpgm
    s_endpgm
    s_endpgm
    s_endpgm
    s_endpgm
    s_endpgm
    s_endpgm
    s_endpgm
    s_endpgm
    s_endpgm
    s_endpgm
    s_endpgm
    s_endpgm
    s_endpgm
    s_endpgm
    s_endpgm
    s_endpgm
    s_endpgm
    s_endpgm
    s_endpgm
    s_endpgm
    s_endpgm
    s_endpgm
    s_endpgm
    s_endpgm
    s_endpgm
    s_endpgm
    s_endpgm
    s_endpgm
    s_endpgm
    s_endpgm
    s_endpgm
    s_endpgm
    s_endpgm
    s_endpgm
    s_endpgm
    s_endpgm
    s_endpgm
    s_endpgm
    s_endpgm
    s_endpgm
    s_endpgm
    s_endpgm
    s_endpgm
    s_endpgm
    s_endpgm
    s_endpgm
    s_endpgm
    s_endpgm
    s_endpgm
    s_endpgm
    s_endpgm
    s_endpgm
    s_endpgm
    s_endpgm
    s_endpgm
    s_endpgm
    s_endpgm
    s_endpgm
    s_endpgm
    s_endpgm
    s_endpgm
    s_endpgm
    s_endpgm
    s_endpgm
    s_endpgm
    s_endpgm
    s_endpgm
    s_endpgm
    s_endpgm
    s_endpgm
    s_endpgm
    s_endpgm
    s_endpgm
    s_endpgm
    s_endpgm
    s_endpgm
    s_endpgm
    s_endpgm
    s_endpgm
    s_endpgm
    s_endpgm
    s_endpgm
    s_endpgm
    s_endpgm
    s_endpgm
    s_endpgm
    s_endpgm
    s_endpgm
    s_endpgm
    s_endpgm
    s_endpgm
    s_endpgm
    s_endpgm
    s_endpgm
    s_endpgm
N_1:
    s_branch L_t0ret
    s_endpgm
    s_endpgm
    s_endpgm
    s_endpgm
    s_endpgm
    s_endpgm
L_cgo:
    s_waitcnt lgkmcnt(0)
    s_barrier
    ds_read_b64_tr_b16 v[192:193], v240 offset:0
    ds_read_b64_tr_b16 v[194:195], v240 offset:2560
    s_waitcnt vmcnt(6)
    ds_read_b128 v[168:171], v244 offset:4352
    ds_read_b64_tr_b16 v[196:197], v240 offset:10240
    ds_read_b64_tr_b16 v[198:199], v240 offset:12800
    ds_read_b128 v[172:175], v245 offset:4352
    ds_read_b64_tr_b16 v[200:201], v240 offset:20480
    ds_read_b64_tr_b16 v[202:203], v240 offset:23040
    ds_read_b128 v[176:179], v246 offset:4352
    s_waitcnt vmcnt(4)
    ds_read_b128 v[188:191], v246 offset:6528
    ds_read_b128 v[184:187], v245 offset:6528
    ds_read_b128 v[180:183], v244 offset:6528
    ds_read_b64_tr_b16 v[204:205], v241 offset:32
    ds_read_b64_tr_b16 v[206:207], v241 offset:2592
    ds_read_b64_tr_b16 v[208:209], v241 offset:10272
    ds_read_b64_tr_b16 v[210:211], v241 offset:12832
    ds_read_b64_tr_b16 v[212:213], v241 offset:20512
    ds_read_b64_tr_b16 v[214:215], v241 offset:23072
    s_waitcnt vmcnt(0)
    ds_read_b128 v[156:159], v244 offset:2176
    ds_read_b128 v[160:163], v245 offset:2176
L_loop:
    s_waitcnt lgkmcnt(9)
    v_mfma_f32_16x16x32_bf16 v[8:11], v[192:195], v[168:171], v[8:11]
    ds_read_b128 v[164:167], v246 offset:2176
    v_mfma_f32_16x16x32_bf16 v[8:11], v[196:199], v[172:175], v[8:11]
    ds_read_b128 v[152:155], v246 offset:0
    v_mfma_f32_16x16x32_bf16 v[8:11], v[200:203], v[176:179], v[8:11]
    ds_read_b128 v[148:151], v245 offset:0
    v_mfma_f32_16x16x32_bf16 v[12:15], v[200:203], v[188:191], v[12:15]
    ds_read_b128 v[144:147], v244 offset:0
    v_mfma_f32_16x16x32_bf16 v[12:15], v[196:199], v[184:187], v[12:15]
    ds_read_b64_tr_b16 v[216:217], v240 offset:64
    s_waitcnt lgkmcnt(9)
    v_mfma_f32_16x16x32_bf16 v[12:15], v[192:195], v[180:183], v[12:15]
    ds_read_b64_tr_b16 v[218:219], v240 offset:2624
    v_mfma_f32_16x16x32_bf16 v[28:31], v[204:207], v[180:183], v[28:31]
    ds_read_b64_tr_b16 v[220:221], v240 offset:10304
    v_mfma_f32_16x16x32_bf16 v[28:31], v[208:211], v[184:187], v[28:31]
    ds_read_b64_tr_b16 v[222:223], v240 offset:12864
    s_waitcnt lgkmcnt(9)
    v_mfma_f32_16x16x32_bf16 v[28:31], v[212:215], v[188:191], v[28:31]
    ds_read_b64_tr_b16 v[224:225], v240 offset:20544
    v_mfma_f32_16x16x32_bf16 v[24:27], v[212:215], v[176:179], v[24:27]
    ds_read_b64_tr_b16 v[226:227], v240 offset:23104
    v_mfma_f32_16x16x32_bf16 v[24:27], v[208:211], v[172:175], v[24:27]
    ds_read_b64_tr_b16 v[228:229], v241 offset:96
    v_mfma_f32_16x16x32_bf16 v[24:27], v[204:207], v[168:171], v[24:27]
    ds_read_b64_tr_b16 v[230:231], v241 offset:2656
    v_mfma_f32_16x16x32_bf16 v[20:23], v[204:207], v[156:159], v[20:23]
    ds_read_b64_tr_b16 v[232:233], v241 offset:10336
    s_waitcnt lgkmcnt(9)
    v_mfma_f32_16x16x32_bf16 v[20:23], v[208:211], v[160:163], v[20:23]
    ds_read_b64_tr_b16 v[234:235], v241 offset:12896
    v_mfma_f32_16x16x32_bf16 v[20:23], v[212:215], v[164:167], v[20:23]
    ds_read_b64_tr_b16 v[236:237], v241 offset:20576
    v_mfma_f32_16x16x32_bf16 v[16:19], v[212:215], v[152:155], v[16:19]
    ds_read_b64_tr_b16 v[238:239], v241 offset:23136
    v_mfma_f32_16x16x32_bf16 v[16:19], v[208:211], v[148:151], v[16:19]
    ds_read_b64_tr_b16 v[208:209], v241 offset:10400
    v_mfma_f32_16x16x32_bf16 v[16:19], v[204:207], v[144:147], v[16:19]
    ds_read_b64_tr_b16 v[204:205], v241 offset:160
    v_mfma_f32_16x16x32_bf16 v[0:3], v[192:195], v[144:147], v[0:3]
    ds_read_b64_tr_b16 v[206:207], v241 offset:2720
    v_mfma_f32_16x16x32_bf16 v[0:3], v[196:199], v[148:151], v[0:3]
    ds_read_b64_tr_b16 v[210:211], v241 offset:12960
    v_mfma_f32_16x16x32_bf16 v[0:3], v[200:203], v[152:155], v[0:3]
    ds_read_b64_tr_b16 v[212:213], v241 offset:20640
    v_mfma_f32_16x16x32_bf16 v[4:7], v[200:203], v[164:167], v[4:7]
    ds_read_b64_tr_b16 v[200:201], v240 offset:20608
    v_mfma_f32_16x16x32_bf16 v[4:7], v[196:199], v[160:163], v[4:7]
    ds_read_b64_tr_b16 v[196:197], v240 offset:10368
    v_mfma_f32_16x16x32_bf16 v[4:7], v[192:195], v[156:159], v[4:7]
    ds_read_b64_tr_b16 v[192:193], v240 offset:128
    s_waitcnt lgkmcnt(9)
    v_mfma_f32_16x16x32_bf16 v[36:39], v[216:219], v[156:159], v[36:39]
    ds_read_b64_tr_b16 v[194:195], v240 offset:2688
    v_mfma_f32_16x16x32_bf16 v[36:39], v[220:223], v[160:163], v[36:39]
    ds_read_b64_tr_b16 v[198:199], v240 offset:12928
    v_mfma_f32_16x16x32_bf16 v[36:39], v[224:227], v[164:167], v[36:39]
    ds_read_b64_tr_b16 v[202:203], v240 offset:23168
    v_mfma_f32_16x16x32_bf16 v[32:35], v[224:227], v[152:155], v[32:35]
    ds_read_b64_tr_b16 v[214:215], v241 offset:23200
    v_mfma_f32_16x16x32_bf16 v[32:35], v[220:223], v[148:151], v[32:35]
    v_add_u32 v244, s63, v244
    v_add_u32 v245, s63, v245
    v_mfma_f32_16x16x32_bf16 v[32:35], v[216:219], v[144:147], v[32:35]
    v_add_u32 v246, s63, v246
    v_mfma_f32_16x16x32_bf16 v[40:43], v[216:219], v[168:171], v[40:43]
    v_mfma_f32_16x16x32_bf16 v[40:43], v[220:223], v[172:175], v[40:43]
    v_mfma_f32_16x16x32_bf16 v[40:43], v[224:227], v[176:179], v[40:43]
    v_mfma_f32_16x16x32_bf16 v[44:47], v[224:227], v[188:191], v[44:47]
    ds_read_b64_tr_b16 v[224:225], v240 offset:20672
    v_mfma_f32_16x16x32_bf16 v[44:47], v[220:223], v[184:187], v[44:47]
    ds_read_b64_tr_b16 v[220:221], v240 offset:10432
    v_mfma_f32_16x16x32_bf16 v[44:47], v[216:219], v[180:183], v[44:47]
    ds_read_b64_tr_b16 v[216:217], v240 offset:192
    v_mfma_f32_16x16x32_bf16 v[60:63], v[228:231], v[180:183], v[60:63]
    ds_read_b64_tr_b16 v[218:219], v240 offset:2752
    v_mfma_f32_16x16x32_bf16 v[60:63], v[232:235], v[184:187], v[60:63]
    ds_read_b64_tr_b16 v[222:223], v240 offset:12992
    s_waitcnt lgkmcnt(5)
    v_mfma_f32_16x16x32_bf16 v[60:63], v[236:239], v[188:191], v[60:63]
    ds_read_b64_tr_b16 v[226:227], v240 offset:23232
    v_mfma_f32_16x16x32_bf16 v[56:59], v[236:239], v[176:179], v[56:59]
    v_mfma_f32_16x16x32_bf16 v[56:59], v[232:235], v[172:175], v[56:59]
    v_mfma_f32_16x16x32_bf16 v[56:59], v[228:231], v[168:171], v[56:59]
    v_mfma_f32_16x16x32_bf16 v[52:55], v[228:231], v[156:159], v[52:55]
    v_mfma_f32_16x16x32_bf16 v[52:55], v[232:235], v[160:163], v[52:55]
    v_mfma_f32_16x16x32_bf16 v[52:55], v[236:239], v[164:167], v[52:55]
    v_mfma_f32_16x16x32_bf16 v[48:51], v[236:239], v[152:155], v[48:51]
    ds_read_b64_tr_b16 v[236:237], v241 offset:20704
    v_mfma_f32_16x16x32_bf16 v[48:51], v[232:235], v[148:151], v[48:51]
    ds_read_b64_tr_b16 v[232:233], v241 offset:10464
    v_mfma_f32_16x16x32_bf16 v[48:51], v[228:231], v[144:147], v[48:51]
    ds_read_b64_tr_b16 v[228:229], v241 offset:224
    v_mfma_f32_16x16x32_bf16 v[64:67], v[192:195], v[144:147], v[64:67]
    ds_read_b64_tr_b16 v[230:231], v241 offset:2784
    v_mfma_f32_16x16x32_bf16 v[64:67], v[196:199], v[148:151], v[64:67]
    ds_read_b64_tr_b16 v[234:235], v241 offset:13024
    v_mfma_f32_16x16x32_bf16 v[64:67], v[200:203], v[152:155], v[64:67]
    ds_read_b64_tr_b16 v[238:239], v241 offset:23264
    v_mfma_f32_16x16x32_bf16 v[68:71], v[200:203], v[164:167], v[68:71]
    v_mfma_f32_16x16x32_bf16 v[68:71], v[196:199], v[160:163], v[68:71]
    v_mfma_f32_16x16x32_bf16 v[68:71], v[192:195], v[156:159], v[68:71]
    v_mfma_f32_16x16x32_bf16 v[72:75], v[192:195], v[168:171], v[72:75]
    v_mfma_f32_16x16x32_bf16 v[72:75], v[196:199], v[172:175], v[72:75]
    v_mfma_f32_16x16x32_bf16 v[72:75], v[200:203], v[176:179], v[72:75]
    v_mfma_f32_16x16x32_bf16 v[76:79], v[200:203], v[188:191], v[76:79]
N_2:
    s_cbranch_execz L_t0ret
    ds_read_b64_tr_b16 v[200:201], v240 offset:20736
    v_mfma_f32_16x16x32_bf16 v[76:79], v[196:199], v[184:187], v[76:79]
    ds_read_b64_tr_b16 v[202:203], v240 offset:23296
    v_mfma_f32_16x16x32_bf16 v[76:79], v[192:195], v[180:183], v[76:79]
    ds_read_b64_tr_b16 v[196:197], v240 offset:10496
    v_mfma_f32_16x16x32_bf16 v[92:95], v[204:207], v[180:183], v[92:95]
    ds_read_b64_tr_b16 v[198:199], v240 offset:13056
    v_mfma_f32_16x16x32_bf16 v[92:95], v[208:211], v[184:187], v[92:95]
    ds_read_b64_tr_b16 v[192:193], v240 offset:256
    v_mfma_f32_16x16x32_bf16 v[92:95], v[212:215], v[188:191], v[92:95]
    ds_read_b64_tr_b16 v[194:195], v240 offset:2816
    v_mfma_f32_16x16x32_bf16 v[88:91], v[212:215], v[176:179], v[88:91]
    v_mfma_f32_16x16x32_bf16 v[88:91], v[208:211], v[172:175], v[88:91]
    v_mfma_f32_16x16x32_bf16 v[88:91], v[204:207], v[168:171], v[88:91]
    v_mfma_f32_16x16x32_bf16 v[84:87], v[204:207], v[156:159], v[84:87]
    v_mfma_f32_16x16x32_bf16 v[84:87], v[208:211], v[160:163], v[84:87]
    v_mfma_f32_16x16x32_bf16 v[84:87], v[212:215], v[164:167], v[84:87]
    v_mfma_f32_16x16x32_bf16 v[80:83], v[212:215], v[152:155], v[80:83]
    ds_read_b64_tr_b16 v[212:213], v241 offset:20768
    v_mfma_f32_16x16x32_bf16 v[80:83], v[208:211], v[148:151], v[80:83]
    ds_read_b64_tr_b16 v[214:215], v241 offset:23328
    v_mfma_f32_16x16x32_bf16 v[80:83], v[204:207], v[144:147], v[80:83]
    ds_read_b64_tr_b16 v[208:209], v241 offset:10528
    s_waitcnt lgkmcnt(3)
    v_mfma_f32_16x16x32_bf16 v[96:99], v[216:219], v[144:147], v[96:99]
    ds_read_b64_tr_b16 v[210:211], v241 offset:13088
    v_mfma_f32_16x16x32_bf16 v[96:99], v[220:223], v[148:151], v[96:99]
    ds_read_b64_tr_b16 v[204:205], v241 offset:288
    v_mfma_f32_16x16x32_bf16 v[96:99], v[224:227], v[152:155], v[96:99]
    ds_read_b64_tr_b16 v[206:207], v241 offset:2848
    v_mfma_f32_16x16x32_bf16 v[100:103], v[224:227], v[164:167], v[100:103]
    s_addk_i32 s54, 30720
    s_cmp_eq_u32 s54, 161920
    v_mfma_f32_16x16x32_bf16 v[100:103], v[220:223], v[160:163], v[100:103]
    s_cselect_b32 s54, 69760, s54
    v_add_u32 v240, s54, v242
    v_mfma_f32_16x16x32_bf16 v[100:103], v[216:219], v[156:159], v[100:103]
    v_add_u32 v241, s54, v243
    s_sub_u32 s55, s55, 1
    v_mfma_f32_16x16x32_bf16 v[104:107], v[216:219], v[168:171], v[104:107]
    s_cmp_eq_u32 s55, 0
    v_mfma_f32_16x16x32_bf16 v[104:107], v[220:223], v[172:175], v[104:107]
    v_mfma_f32_16x16x32_bf16 v[104:107], v[224:227], v[176:179], v[104:107]
    v_mfma_f32_16x16x32_bf16 v[108:111], v[224:227], v[188:191], v[108:111]
    v_mfma_f32_16x16x32_bf16 v[108:111], v[220:223], v[184:187], v[108:111]
    v_mfma_f32_16x16x32_bf16 v[108:111], v[216:219], v[180:183], v[108:111]
    v_mfma_f32_16x16x32_bf16 v[124:127], v[228:231], v[180:183], v[124:127]
    v_mfma_f32_16x16x32_bf16 v[124:127], v[232:235], v[184:187], v[124:127]
    v_mfma_f32_16x16x32_bf16 v[124:127], v[236:239], v[188:191], v[124:127]
    v_mfma_f32_16x16x32_bf16 v[120:123], v[236:239], v[176:179], v[120:123]
    s_waitcnt lgkmcnt(0)
    s_barrier
    s_cbranch_scc1 L_epi
    v_mfma_f32_16x16x32_bf16 v[120:123], v[232:235], v[172:175], v[120:123]
    ds_read_b64_tr_b16 v[216:217], v240 offset:0
    v_mfma_f32_16x16x32_bf16 v[120:123], v[228:231], v[168:171], v[120:123]
    ds_read_b64_tr_b16 v[218:219], v240 offset:2560
    v_mfma_f32_16x16x32_bf16 v[116:119], v[228:231], v[156:159], v[116:119]
    ds_read_b128 v[168:171], v247 offset:4352
    v_mfma_f32_16x16x32_bf16 v[116:119], v[232:235], v[160:163], v[116:119]
    ds_read_b64_tr_b16 v[220:221], v240 offset:10240
    v_mfma_f32_16x16x32_bf16 v[116:119], v[236:239], v[164:167], v[116:119]
    ds_read_b64_tr_b16 v[222:223], v240 offset:12800
    v_mfma_f32_16x16x32_bf16 v[112:115], v[236:239], v[152:155], v[112:115]
    ds_read_b128 v[172:175], v248 offset:4352
    v_mfma_f32_16x16x32_bf16 v[112:115], v[232:235], v[148:151], v[112:115]
    ds_read_b64_tr_b16 v[224:225], v240 offset:20480
    v_mfma_f32_16x16x32_bf16 v[112:115], v[228:231], v[144:147], v[112:115]
    ds_read_b64_tr_b16 v[226:227], v240 offset:23040
    v_mfma_f32_16x16x32_bf16 v[128:131], v[192:195], v[144:147], v[128:131]
    ds_read_b128 v[176:179], v249 offset:4352
    v_mfma_f32_16x16x32_bf16 v[128:131], v[196:199], v[148:151], v[128:131]
    ds_read_b128 v[188:191], v249 offset:6528
    v_mfma_f32_16x16x32_bf16 v[128:131], v[200:203], v[152:155], v[128:131]
    ds_read_b128 v[184:187], v248 offset:6528
    v_mfma_f32_16x16x32_bf16 v[132:135], v[200:203], v[164:167], v[132:135]
    ds_read_b128 v[180:183], v247 offset:6528
    v_mfma_f32_16x16x32_bf16 v[132:135], v[196:199], v[160:163], v[132:135]
    ds_read_b64_tr_b16 v[228:229], v241 offset:32
    v_mfma_f32_16x16x32_bf16 v[132:135], v[192:195], v[156:159], v[132:135]
    ds_read_b64_tr_b16 v[230:231], v241 offset:2592
    v_mfma_f32_16x16x32_bf16 v[140:143], v[204:207], v[156:159], v[140:143]
    ds_read_b64_tr_b16 v[232:233], v241 offset:10272
    v_mfma_f32_16x16x32_bf16 v[140:143], v[208:211], v[160:163], v[140:143]
    ds_read_b64_tr_b16 v[234:235], v241 offset:12832
    v_mfma_f32_16x16x32_bf16 v[140:143], v[212:215], v[164:167], v[140:143]
    ds_read_b64_tr_b16 v[236:237], v241 offset:20512
    v_mfma_f32_16x16x32_bf16 v[136:139], v[212:215], v[152:155], v[136:139]
    ds_read_b64_tr_b16 v[238:239], v241 offset:23072
    v_mfma_f32_16x16x32_bf16 v[136:139], v[208:211], v[148:151], v[136:139]
    ds_read_b128 v[156:159], v247 offset:2176
    v_mfma_f32_16x16x32_bf16 v[136:139], v[204:207], v[144:147], v[136:139]
    ds_read_b128 v[160:163], v248 offset:2176
    s_waitcnt lgkmcnt(9)
    v_mfma_f32_16x16x32_bf16 v[8:11], v[216:219], v[168:171], v[8:11]
    ds_read_b128 v[164:167], v249 offset:2176
    v_mfma_f32_16x16x32_bf16 v[8:11], v[220:223], v[172:175], v[8:11]
    ds_read_b128 v[152:155], v249 offset:0
    v_mfma_f32_16x16x32_bf16 v[8:11], v[224:227], v[176:179], v[8:11]
    ds_read_b128 v[148:151], v248 offset:0
    v_mfma_f32_16x16x32_bf16 v[12:15], v[224:227], v[188:191], v[12:15]
    ds_read_b128 v[144:147], v247 offset:0
    v_mfma_f32_16x16x32_bf16 v[12:15], v[220:223], v[184:187], v[12:15]
    ds_read_b64_tr_b16 v[192:193], v240 offset:64
    s_waitcnt lgkmcnt(9)
    v_mfma_f32_16x16x32_bf16 v[12:15], v[216:219], v[180:183], v[12:15]
    ds_read_b64_tr_b16 v[194:195], v240 offset:2624
    v_mfma_f32_16x16x32_bf16 v[28:31], v[228:231], v[180:183], v[28:31]
    ds_read_b64_tr_b16 v[196:197], v240 offset:10304
    v_mfma_f32_16x16x32_bf16 v[28:31], v[232:235], v[184:187], v[28:31]
    ds_read_b64_tr_b16 v[198:199], v240 offset:12864
    s_waitcnt lgkmcnt(9)
    v_mfma_f32_16x16x32_bf16 v[28:31], v[236:239], v[188:191], v[28:31]
    ds_read_b64_tr_b16 v[200:201], v240 offset:20544
    v_mfma_f32_16x16x32_bf16 v[24:27], v[236:239], v[176:179], v[24:27]
    ds_read_b64_tr_b16 v[202:203], v240 offset:23104
    v_mfma_f32_16x16x32_bf16 v[24:27], v[232:235], v[172:175], v[24:27]
    ds_read_b64_tr_b16 v[204:205], v241 offset:96
    v_mfma_f32_16x16x32_bf16 v[24:27], v[228:231], v[168:171], v[24:27]
    ds_read_b64_tr_b16 v[206:207], v241 offset:2656
    v_mfma_f32_16x16x32_bf16 v[20:23], v[228:231], v[156:159], v[20:23]
    ds_read_b64_tr_b16 v[208:209], v241 offset:10336
    s_waitcnt lgkmcnt(9)
    v_mfma_f32_16x16x32_bf16 v[20:23], v[232:235], v[160:163], v[20:23]
    ds_read_b64_tr_b16 v[210:211], v241 offset:12896
    v_mfma_f32_16x16x32_bf16 v[20:23], v[236:239], v[164:167], v[20:23]
    ds_read_b64_tr_b16 v[212:213], v241 offset:20576
    v_mfma_f32_16x16x32_bf16 v[16:19], v[236:239], v[152:155], v[16:19]
    ds_read_b64_tr_b16 v[214:215], v241 offset:23136
    v_mfma_f32_16x16x32_bf16 v[16:19], v[232:235], v[148:151], v[16:19]
    ds_read_b64_tr_b16 v[232:233], v241 offset:10400
    v_mfma_f32_16x16x32_bf16 v[16:19], v[228:231], v[144:147], v[16:19]
    ds_read_b64_tr_b16 v[228:229], v241 offset:160
    v_mfma_f32_16x16x32_bf16 v[0:3], v[216:219], v[144:147], v[0:3]
N_3:
    s_cbranch_execz L_t0ret
    ds_read_b64_tr_b16 v[230:231], v241 offset:2720
    v_mfma_f32_16x16x32_bf16 v[0:3], v[220:223], v[148:151], v[0:3]
    ds_read_b64_tr_b16 v[234:235], v241 offset:12960
    v_mfma_f32_16x16x32_bf16 v[0:3], v[224:227], v[152:155], v[0:3]
    ds_read_b64_tr_b16 v[236:237], v241 offset:20640
    v_mfma_f32_16x16x32_bf16 v[4:7], v[224:227], v[164:167], v[4:7]
    ds_read_b64_tr_b16 v[224:225], v240 offset:20608
    v_mfma_f32_16x16x32_bf16 v[4:7], v[220:223], v[160:163], v[4:7]
    ds_read_b64_tr_b16 v[220:221], v240 offset:10368
    v_mfma_f32_16x16x32_bf16 v[4:7], v[216:219], v[156:159], v[4:7]
    ds_read_b64_tr_b16 v[216:217], v240 offset:128
    s_waitcnt lgkmcnt(9)
    v_mfma_f32_16x16x32_bf16 v[36:39], v[192:195], v[156:159], v[36:39]
    ds_read_b64_tr_b16 v[218:219], v240 offset:2688
    v_mfma_f32_16x16x32_bf16 v[36:39], v[196:199], v[160:163], v[36:39]
    ds_read_b64_tr_b16 v[222:223], v240 offset:12928
    v_mfma_f32_16x16x32_bf16 v[36:39], v[200:203], v[164:167], v[36:39]
    ds_read_b64_tr_b16 v[226:227], v240 offset:23168
    v_mfma_f32_16x16x32_bf16 v[32:35], v[200:203], v[152:155], v[32:35]
    ds_read_b64_tr_b16 v[238:239], v241 offset:23200
    v_mfma_f32_16x16x32_bf16 v[32:35], v[196:199], v[148:151], v[32:35]
    v_add_u32 v247, s63, v247
    v_add_u32 v248, s63, v248
    v_mfma_f32_16x16x32_bf16 v[32:35], v[192:195], v[144:147], v[32:35]
    v_add_u32 v249, s63, v249
    s_sub_u32 s63, 0, s63
    v_mfma_f32_16x16x32_bf16 v[40:43], v[192:195], v[168:171], v[40:43]
    v_mfma_f32_16x16x32_bf16 v[40:43], v[196:199], v[172:175], v[40:43]
    v_mfma_f32_16x16x32_bf16 v[40:43], v[200:203], v[176:179], v[40:43]
    v_mfma_f32_16x16x32_bf16 v[44:47], v[200:203], v[188:191], v[44:47]
    ds_read_b64_tr_b16 v[200:201], v240 offset:20672
    v_mfma_f32_16x16x32_bf16 v[44:47], v[196:199], v[184:187], v[44:47]
    ds_read_b64_tr_b16 v[196:197], v240 offset:10432
    v_mfma_f32_16x16x32_bf16 v[44:47], v[192:195], v[180:183], v[44:47]
    ds_read_b64_tr_b16 v[192:193], v240 offset:192
    v_mfma_f32_16x16x32_bf16 v[60:63], v[204:207], v[180:183], v[60:63]
    ds_read_b64_tr_b16 v[194:195], v240 offset:2752
    v_mfma_f32_16x16x32_bf16 v[60:63], v[208:211], v[184:187], v[60:63]
    ds_read_b64_tr_b16 v[198:199], v240 offset:12992
    s_waitcnt lgkmcnt(5)
    v_mfma_f32_16x16x32_bf16 v[60:63], v[212:215], v[188:191], v[60:63]
    ds_read_b64_tr_b16 v[202:203], v240 offset:23232
    v_mfma_f32_16x16x32_bf16 v[56:59], v[212:215], v[176:179], v[56:59]
    v_mfma_f32_16x16x32_bf16 v[56:59], v[208:211], v[172:175], v[56:59]
    v_mfma_f32_16x16x32_bf16 v[56:59], v[204:207], v[168:171], v[56:59]
    v_mfma_f32_16x16x32_bf16 v[52:55], v[204:207], v[156:159], v[52:55]
    v_mfma_f32_16x16x32_bf16 v[52:55], v[208:211], v[160:163], v[52:55]
    v_mfma_f32_16x16x32_bf16 v[52:55], v[212:215], v[164:167], v[52:55]
    v_mfma_f32_16x16x32_bf16 v[48:51], v[212:215], v[152:155], v[48:51]
    ds_read_b64_tr_b16 v[212:213], v241 offset:20704
    v_mfma_f32_16x16x32_bf16 v[48:51], v[208:211], v[148:151], v[48:51]
    ds_read_b64_tr_b16 v[208:209], v241 offset:10464
    v_mfma_f32_16x16x32_bf16 v[48:51], v[204:207], v[144:147], v[48:51]
    ds_read_b64_tr_b16 v[204:205], v241 offset:224
    v_mfma_f32_16x16x32_bf16 v[64:67], v[216:219], v[144:147], v[64:67]
    ds_read_b64_tr_b16 v[206:207], v241 offset:2784
    v_mfma_f32_16x16x32_bf16 v[64:67], v[220:223], v[148:151], v[64:67]
    ds_read_b64_tr_b16 v[210:211], v241 offset:13024
    v_mfma_f32_16x16x32_bf16 v[64:67], v[224:227], v[152:155], v[64:67]
    ds_read_b64_tr_b16 v[214:215], v241 offset:23264
    v_mfma_f32_16x16x32_bf16 v[68:71], v[224:227], v[164:167], v[68:71]
    v_mfma_f32_16x16x32_bf16 v[68:71], v[220:223], v[160:163], v[68:71]
    v_mfma_f32_16x16x32_bf16 v[68:71], v[216:219], v[156:159], v[68:71]
    v_mfma_f32_16x16x32_bf16 v[72:75], v[216:219], v[168:171], v[72:75]
    v_mfma_f32_16x16x32_bf16 v[72:75], v[220:223], v[172:175], v[72:75]
    v_mfma_f32_16x16x32_bf16 v[72:75], v[224:227], v[176:179], v[72:75]
    v_mfma_f32_16x16x32_bf16 v[76:79], v[224:227], v[188:191], v[76:79]
    ds_read_b64_tr_b16 v[224:225], v240 offset:20736
    v_mfma_f32_16x16x32_bf16 v[76:79], v[220:223], v[184:187], v[76:79]
    ds_read_b64_tr_b16 v[226:227], v240 offset:23296
    v_mfma_f32_16x16x32_bf16 v[76:79], v[216:219], v[180:183], v[76:79]
    ds_read_b64_tr_b16 v[220:221], v240 offset:10496
    v_mfma_f32_16x16x32_bf16 v[92:95], v[228:231], v[180:183], v[92:95]
    ds_read_b64_tr_b16 v[222:223], v240 offset:13056
    v_mfma_f32_16x16x32_bf16 v[92:95], v[232:235], v[184:187], v[92:95]
    ds_read_b64_tr_b16 v[216:217], v240 offset:256
    v_mfma_f32_16x16x32_bf16 v[92:95], v[236:239], v[188:191], v[92:95]
    ds_read_b64_tr_b16 v[218:219], v240 offset:2816
    v_mfma_f32_16x16x32_bf16 v[88:91], v[236:239], v[176:179], v[88:91]
    v_mfma_f32_16x16x32_bf16 v[88:91], v[232:235], v[172:175], v[88:91]
    v_mfma_f32_16x16x32_bf16 v[88:91], v[228:231], v[168:171], v[88:91]
    v_mfma_f32_16x16x32_bf16 v[84:87], v[228:231], v[156:159], v[84:87]
    v_mfma_f32_16x16x32_bf16 v[84:87], v[232:235], v[160:163], v[84:87]
    v_mfma_f32_16x16x32_bf16 v[84:87], v[236:239], v[164:167], v[84:87]
    v_mfma_f32_16x16x32_bf16 v[80:83], v[236:239], v[152:155], v[80:83]
    ds_read_b64_tr_b16 v[236:237], v241 offset:20768
    v_mfma_f32_16x16x32_bf16 v[80:83], v[232:235], v[148:151], v[80:83]
    ds_read_b64_tr_b16 v[238:239], v241 offset:23328
    v_mfma_f32_16x16x32_bf16 v[80:83], v[228:231], v[144:147], v[80:83]
    ds_read_b64_tr_b16 v[232:233], v241 offset:10528
    s_waitcnt lgkmcnt(3)
    v_mfma_f32_16x16x32_bf16 v[96:99], v[192:195], v[144:147], v[96:99]
    ds_read_b64_tr_b16 v[234:235], v241 offset:13088
    v_mfma_f32_16x16x32_bf16 v[96:99], v[196:199], v[148:151], v[96:99]
    ds_read_b64_tr_b16 v[228:229], v241 offset:288
    v_mfma_f32_16x16x32_bf16 v[96:99], v[200:203], v[152:155], v[96:99]
    ds_read_b64_tr_b16 v[230:231], v241 offset:2848
    v_mfma_f32_16x16x32_bf16 v[100:103], v[200:203], v[164:167], v[100:103]
    s_addk_i32 s54, 30720
    s_cmp_eq_u32 s54, 161920
    v_mfma_f32_16x16x32_bf16 v[100:103], v[196:199], v[160:163], v[100:103]
    s_cselect_b32 s54, 69760, s54
    v_add_u32 v240, s54, v242
    v_mfma_f32_16x16x32_bf16 v[100:103], v[192:195], v[156:159], v[100:103]
    v_add_u32 v241, s54, v243
    v_mfma_f32_16x16x32_bf16 v[104:107], v[192:195], v[168:171], v[104:107]
    v_mfma_f32_16x16x32_bf16 v[104:107], v[196:199], v[172:175], v[104:107]
    v_mfma_f32_16x16x32_bf16 v[104:107], v[200:203], v[176:179], v[104:107]
    v_mfma_f32_16x16x32_bf16 v[108:111], v[200:203], v[188:191], v[108:111]
    v_mfma_f32_16x16x32_bf16 v[108:111], v[196:199], v[184:187], v[108:111]
    v_mfma_f32_16x16x32_bf16 v[108:111], v[192:195], v[180:183], v[108:111]
    v_mfma_f32_16x16x32_bf16 v[124:127], v[204:207], v[180:183], v[124:127]
    v_mfma_f32_16x16x32_bf16 v[124:127], v[208:211], v[184:187], v[124:127]
    v_mfma_f32_16x16x32_bf16 v[124:127], v[212:215], v[188:191], v[124:127]
    v_mfma_f32_16x16x32_bf16 v[120:123], v[212:215], v[176:179], v[120:123]
    s_waitcnt lgkmcnt(0)
    s_barrier
    v_mfma_f32_16x16x32_bf16 v[120:123], v[208:211], v[172:175], v[120:123]
    ds_read_b64_tr_b16 v[192:193], v240 offset:0
    v_mfma_f32_16x16x32_bf16 v[120:123], v[204:207], v[168:171], v[120:123]
    ds_read_b64_tr_b16 v[194:195], v240 offset:2560
    v_mfma_f32_16x16x32_bf16 v[116:119], v[204:207], v[156:159], v[116:119]
    ds_read_b128 v[168:171], v244 offset:4352
    v_mfma_f32_16x16x32_bf16 v[116:119], v[208:211], v[160:163], v[116:119]
    ds_read_b64_tr_b16 v[196:197], v240 offset:10240
    v_mfma_f32_16x16x32_bf16 v[116:119], v[212:215], v[164:167], v[116:119]
    ds_read_b64_tr_b16 v[198:199], v240 offset:12800
    v_mfma_f32_16x16x32_bf16 v[112:115], v[212:215], v[152:155], v[112:115]
    ds_read_b128 v[172:175], v245 offset:4352
    v_mfma_f32_16x16x32_bf16 v[112:115], v[208:211], v[148:151], v[112:115]
    ds_read_b64_tr_b16 v[200:201], v240 offset:20480
    v_mfma_f32_16x16x32_bf16 v[112:115], v[204:207], v[144:147], v[112:115]
    ds_read_b64_tr_b16 v[202:203], v240 offset:23040
N_4:
    s_cbranch_execz L_t0ret
    v_mfma_f32_16x16x32_bf16 v[128:131], v[216:219], v[144:147], v[128:131]
    ds_read_b128 v[176:179], v246 offset:4352
    v_mfma_f32_16x16x32_bf16 v[128:131], v[220:223], v[148:151], v[128:131]
    ds_read_b128 v[188:191], v246 offset:6528
    v_mfma_f32_16x16x32_bf16 v[128:131], v[224:227], v[152:155], v[128:131]
    ds_read_b128 v[184:187], v245 offset:6528
    v_mfma_f32_16x16x32_bf16 v[132:135], v[224:227], v[164:167], v[132:135]
    ds_read_b128 v[180:183], v244 offset:6528
    v_mfma_f32_16x16x32_bf16 v[132:135], v[220:223], v[160:163], v[132:135]
    ds_read_b64_tr_b16 v[204:205], v241 offset:32
    v_mfma_f32_16x16x32_bf16 v[132:135], v[216:219], v[156:159], v[132:135]
    ds_read_b64_tr_b16 v[206:207], v241 offset:2592
    v_mfma_f32_16x16x32_bf16 v[140:143], v[228:231], v[156:159], v[140:143]
    ds_read_b64_tr_b16 v[208:209], v241 offset:10272
    v_mfma_f32_16x16x32_bf16 v[140:143], v[232:235], v[160:163], v[140:143]
    ds_read_b64_tr_b16 v[210:211], v241 offset:12832
    v_mfma_f32_16x16x32_bf16 v[140:143], v[236:239], v[164:167], v[140:143]
    ds_read_b64_tr_b16 v[212:213], v241 offset:20512
    v_mfma_f32_16x16x32_bf16 v[136:139], v[236:239], v[152:155], v[136:139]
    ds_read_b64_tr_b16 v[214:215], v241 offset:23072
    v_mfma_f32_16x16x32_bf16 v[136:139], v[232:235], v[148:151], v[136:139]
    ds_read_b128 v[156:159], v244 offset:2176
    v_mfma_f32_16x16x32_bf16 v[136:139], v[228:231], v[144:147], v[136:139]
    ds_read_b128 v[160:163], v245 offset:2176
    s_branch L_loop
L_csetup:
    s_lshl_b32 s53, s51, 3
    v_add_u32 v1, s53, v148
    v_mul_u32_u24 v1, 2176, v1
    v_lshl_add_u32 v1, v149, 4, v1
    v_mov_b64 v[4:5], 0
    v_mov_b64 v[6:7], 0
    ds_write_b128 v1, v[4:7]
    v_lshlrev_b32 v2, 4, v149
    v_add_u32 v2, 69632, v2
    ds_write_b128 v2, v[4:7]
    s_mov_b32 s28, s16
    s_and_b32 s29, s17, 0xffff
    s_mov_b32 s30, s22
    s_mov_b32 s31, 0x20000
    s_mov_b32 s58, 0x3fb8aa3b
    s_mov_b32 s59, s58
    s_mov_b32 s63, 34816
    v_lshrrev_b32 v151, 4, v252
    v_and_b32 v150, 15, v252
    v_add_u32 v148, 15, v150
    v_and_b32 v148, 6, v148
    v_xor_b32 v148, v148, v151
    v_lshlrev_b32 v148, 4, v148
    v_lshl_add_u32 v148, v150, 7, v148
    v_add_u32 v244, s52, v148
    v_xor_b32 v247, 64, v244
    v_add_u32 v148, 16, v150
    v_and_b32 v148, 6, v148
    v_xor_b32 v148, v148, v151
    v_lshlrev_b32 v148, 4, v148
    v_lshl_add_u32 v148, v150, 7, v148
    s_addk_i32 s52, 128
    v_add_u32 v245, s52, v148
    v_xor_b32 v248, 64, v245
    v_add_u32 v148, 17, v150
    v_and_b32 v148, 6, v148
    v_xor_b32 v148, v148, v151
    v_lshlrev_b32 v148, 4, v148
    v_lshl_add_u32 v148, v150, 7, v148
    s_addk_i32 s52, 128
    v_add_u32 v246, s52, v148
    v_xor_b32 v249, 64, v246
    v_mul_u32_u24 v251, 1152, v150
    v_lshrrev_b32 v148, 1, v151
    v_lshl_add_u32 v251, v148, 4, v251
    v_and_b32 v149, 1, v151
    v_lshl_add_u32 v251, v149, 5, v251
    v_lshlrev_b32 v250, 4, v151
    v_add_u32 v250, 161920, v250
    v_lshlrev_b32 v148, 4, v148
    v_lshl_add_u32 v148, v149, 2, v148
    v_bfe_u32 v150, v252, 2, 2
    v_add_u32 v148, v148, v150
    v_mul_u32_u24 v148, 320, v148
    v_and_b32 v150, 3, v252
    v_lshl_add_u32 v148, v150, 3, v148
    v_lshlrev_b32 v149, 5, v149
    v_add_u32 v242, v148, v149
    v_sub_u32 v243, v148, v149
    s_mov_b32 s54, 69760
    v_add_u32 v240, s54, v242
    v_add_u32 v241, s54, v243
    s_add_u32 s56, s56, s50
    s_mul_i32 s60, s57, 36864
    s_add_u32 s61, s56, s60
    s_xor_b32 s60, s60, 36864
    s_add_u32 s62, s56, s60
    s_lshl_b32 s60, s57, 6
    s_add_u32 s64, s61, s60
    s_add_u32 s65, s64, 18432
    s_add_u32 s66, s62, s60
    s_add_u32 s67, s66, 18432
    s_lshl_b32 s60, s57, 8
    s_sub_u32 s68, s61, s60
    s_addk_i32 s68, 256
    s_add_u32 s69, s68, 18432
    v_mov_b64 v[0:1], 0
    v_mov_b64 v[2:3], 0
    v_mov_b64 v[4:5], 0
    v_mov_b64 v[6:7], 0
    v_mov_b64 v[8:9], 0
    v_mov_b64 v[10:11], 0
    v_mov_b64 v[12:13], 0
    v_mov_b64 v[14:15], 0
    v_mov_b64 v[16:17], 0
    v_mov_b64 v[18:19], 0
    v_mov_b64 v[20:21], 0
    v_mov_b64 v[22:23], 0
    v_mov_b64 v[24:25], 0
    v_mov_b64 v[26:27], 0
    v_mov_b64 v[28:29], 0
    v_mov_b64 v[30:31], 0
    v_mov_b64 v[32:33], 0
    v_mov_b64 v[34:35], 0
    v_mov_b64 v[36:37], 0
    v_mov_b64 v[38:39], 0
    v_mov_b64 v[40:41], 0
    v_mov_b64 v[42:43], 0
    v_mov_b64 v[44:45], 0
    v_mov_b64 v[46:47], 0
    v_mov_b64 v[48:49], 0
    v_mov_b64 v[50:51], 0
    v_mov_b64 v[52:53], 0
    v_mov_b64 v[54:55], 0
    v_mov_b64 v[56:57], 0
    v_mov_b64 v[58:59], 0
    v_mov_b64 v[60:61], 0
    v_mov_b64 v[62:63], 0
    v_mov_b64 v[64:65], 0
    v_mov_b64 v[66:67], 0
    v_mov_b64 v[68:69], 0
    v_mov_b64 v[70:71], 0
    v_mov_b64 v[72:73], 0
    v_mov_b64 v[74:75], 0
    v_mov_b64 v[76:77], 0
    v_mov_b64 v[78:79], 0
    v_mov_b64 v[80:81], 0
    v_mov_b64 v[82:83], 0
    v_mov_b64 v[84:85], 0
    v_mov_b64 v[86:87], 0
    v_mov_b64 v[88:89], 0
    v_mov_b64 v[90:91], 0
    v_mov_b64 v[92:93], 0
    v_mov_b64 v[94:95], 0
    v_mov_b64 v[96:97], 0
    v_mov_b64 v[98:99], 0
    v_mov_b64 v[100:101], 0
    v_mov_b64 v[102:103], 0
    v_mov_b64 v[104:105], 0
    v_mov_b64 v[106:107], 0
    v_mov_b64 v[108:109], 0
    v_mov_b64 v[110:111], 0
    v_mov_b64 v[112:113], 0
    v_mov_b64 v[114:115], 0
    v_mov_b64 v[116:117], 0
    v_mov_b64 v[118:119], 0
    v_mov_b64 v[120:121], 0
    v_mov_b64 v[122:123], 0
    v_mov_b64 v[124:125], 0
    v_mov_b64 v[126:127], 0
    v_mov_b64 v[128:129], 0
    v_mov_b64 v[130:131], 0
    v_mov_b64 v[132:133], 0
    v_mov_b64 v[134:135], 0
    v_mov_b64 v[136:137], 0
    v_mov_b64 v[138:139], 0
    v_mov_b64 v[140:141], 0
    v_mov_b64 v[142:143], 0
    s_mov_b32 s55, 9
    s_branch L_cgo
    s_endpgm
    s_endpgm
    s_endpgm
    s_endpgm
    s_endpgm
    s_endpgm
    s_endpgm
    s_endpgm
    s_endpgm
    s_endpgm
    s_endpgm
    s_endpgm
    s_endpgm
    s_endpgm
    s_endpgm
    s_endpgm
    s_endpgm
    s_endpgm
    s_endpgm
    s_endpgm
    s_endpgm
    s_endpgm
    s_endpgm
    s_endpgm
    s_endpgm
    s_endpgm
    s_endpgm
    s_endpgm
    s_endpgm
    s_endpgm
N_5:
    s_branch L_tret
L_epi:
    v_mfma_f32_16x16x32_bf16 v[120:123], v[232:235], v[172:175], v[120:123]
    ds_read_b64_tr_b16 v[216:217], v240 offset:0
    v_mfma_f32_16x16x32_bf16 v[120:123], v[228:231], v[168:171], v[120:123]
    ds_read_b64_tr_b16 v[218:219], v240 offset:2560
    v_mfma_f32_16x16x32_bf16 v[116:119], v[228:231], v[156:159], v[116:119]
    ds_read_b128 v[168:171], v247 offset:4352
    v_mfma_f32_16x16x32_bf16 v[116:119], v[232:235], v[160:163], v[116:119]
    ds_read_b64_tr_b16 v[220:221], v240 offset:10240
    v_mfma_f32_16x16x32_bf16 v[116:119], v[236:239], v[164:167], v[116:119]
    ds_read_b64_tr_b16 v[222:223], v240 offset:12800
    v_mfma_f32_16x16x32_bf16 v[112:115], v[236:239], v[152:155], v[112:115]
    ds_read_b128 v[172:175], v248 offset:4352
    v_mfma_f32_16x16x32_bf16 v[112:115], v[232:235], v[148:151], v[112:115]
    ds_read_b64_tr_b16 v[224:225], v240 offset:20480
    v_mfma_f32_16x16x32_bf16 v[112:115], v[228:231], v[144:147], v[112:115]
    ds_read_b64_tr_b16 v[226:227], v240 offset:23040
    v_mfma_f32_16x16x32_bf16 v[128:131], v[192:195], v[144:147], v[128:131]
    ds_read_b128 v[176:179], v249 offset:4352
    v_mfma_f32_16x16x32_bf16 v[128:131], v[196:199], v[148:151], v[128:131]
    ds_read_b64_tr_b16 v[252:253], v241 offset:20512
    v_mfma_f32_16x16x32_bf16 v[128:131], v[200:203], v[152:155], v[128:131]
    ds_read_b64_tr_b16 v[254:255], v241 offset:23072
    v_mfma_f32_16x16x32_bf16 v[132:135], v[200:203], v[164:167], v[132:135]
    ds_read_b64_tr_b16 v[236:237], v241 offset:10272
    v_mfma_f32_16x16x32_bf16 v[132:135], v[196:199], v[160:163], v[132:135]
    ds_read_b64_tr_b16 v[238:239], v241 offset:12832
    v_mfma_f32_16x16x32_bf16 v[132:135], v[192:195], v[156:159], v[132:135]
    ds_read_b64_tr_b16 v[232:233], v241 offset:32
    v_mfma_f32_16x16x32_bf16 v[140:143], v[204:207], v[156:159], v[140:143]
    ds_read_b64_tr_b16 v[234:235], v241 offset:2592
    v_mfma_f32_16x16x32_bf16 v[140:143], v[208:211], v[160:163], v[140:143]
    ds_read_b128 v[180:183], v247 offset:6528
    v_mfma_f32_16x16x32_bf16 v[140:143], v[212:215], v[164:167], v[140:143]
    ds_read_b128 v[184:187], v248 offset:6528
    v_mfma_f32_16x16x32_bf16 v[136:139], v[212:215], v[152:155], v[136:139]
    ds_read_b128 v[188:191], v249 offset:6528
    v_mfma_f32_16x16x32_bf16 v[136:139], v[208:211], v[148:151], v[136:139]
    ds_read_b128 v[228:231], v250 offset:0
    v_mfma_f32_16x16x32_bf16 v[136:139], v[204:207], v[144:147], v[136:139]
    ds_read_b128 v[200:203], v250 offset:64
    s_waitcnt lgkmcnt(10)
    v_mfma_f32_16x16x32_bf16 v[8:11], v[216:219], v[168:171], v[8:11]
    ds_read_b128 v[196:199], v250 offset:128
    v_mfma_f32_16x16x32_bf16 v[8:11], v[220:223], v[172:175], v[8:11]
    ds_read_b128 v[192:195], v250 offset:192
    v_mfma_f32_16x16x32_bf16 v[8:11], v[224:227], v[176:179], v[8:11]
    ds_read_b128 v[156:159], v247 offset:2176
    s_waitcnt lgkmcnt(10)
    v_mfma_f32_16x16x32_bf16 v[24:27], v[252:255], v[176:179], v[24:27]
    ds_read_b128 v[160:163], v248 offset:2176
    v_mfma_f32_16x16x32_bf16 v[24:27], v[236:239], v[172:175], v[24:27]
    ds_read_b128 v[164:167], v249 offset:2176
    s_waitcnt lgkmcnt(9)
    v_mfma_f32_16x16x32_bf16 v[24:27], v[232:235], v[168:171], v[24:27]
    ds_read_b128 v[144:147], v247 offset:0
    v_mfma_f32_16x16x32_bf16 v[28:31], v[232:235], v[180:183], v[28:31]
    ds_read_b128 v[148:151], v248 offset:0
    s_waitcnt lgkmcnt(9)
    v_mfma_f32_16x16x32_bf16 v[28:31], v[236:239], v[184:187], v[28:31]
    ds_read_b128 v[152:155], v249 offset:0
    v_mfma_f32_16x16x32_bf16 v[28:31], v[252:255], v[188:191], v[28:31]
    ds_read_b64_tr_b16 v[212:213], v240 offset:64
    v_mfma_f32_16x16x32_bf16 v[12:15], v[224:227], v[188:191], v[12:15]
    ds_read_b64_tr_b16 v[214:215], v240 offset:2624
    v_mfma_f32_16x16x32_bf16 v[12:15], v[220:223], v[184:187], v[12:15]
    ds_read_b64_tr_b16 v[208:209], v240 offset:10304
    v_mfma_f32_16x16x32_bf16 v[12:15], v[216:219], v[180:183], v[12:15]
    ds_read_b64_tr_b16 v[210:211], v240 offset:12864
    s_waitcnt lgkmcnt(9)
    v_pk_fma_f32 v[8:9], v[8:9], v[228:229], v[200:201]
    v_pk_fma_f32 v[10:11], v[10:11], v[230:231], v[202:203]
    v_pk_fma_f32 v[24:25], v[24:25], v[196:197], v[192:193]
    v_pk_fma_f32 v[26:27], v[26:27], v[198:199], v[194:195]
    v_mfma_f32_16x16x32_bf16 v[4:7], v[216:219], v[156:159], v[4:7]
    ds_read_b64_tr_b16 v[204:205], v240 offset:20544
    v_exp_f32_e64 v242, -v8
    v_exp_f32_e64 v243, -v9
    s_waitcnt lgkmcnt(8)
    v_mfma_f32_16x16x32_bf16 v[4:7], v[220:223], v[160:163], v[4:7]
    ds_read_b64_tr_b16 v[206:207], v240 offset:23104
    v_exp_f32_e64 v244, -v10
    v_exp_f32_e64 v245, -v11
    v_mfma_f32_16x16x32_bf16 v[4:7], v[224:227], v[164:167], v[4:7]
    v_exp_f32_e64 v246, -v24
    v_exp_f32_e64 v247, -v25
    v_exp_f32_e64 v248, -v26
    v_exp_f32_e64 v249, -v27
    v_pk_fma_f32 v[242:243], v[242:243], s[58:59], s[58:59]
    v_pk_fma_f32 v[244:245], v[244:245], s[58:59], s[58:59]
    v_pk_fma_f32 v[246:247], v[246:247], s[58:59], s[58:59]
    v_pk_fma_f32 v[248:249], v[248:249], s[58:59], s[58:59]
    v_mfma_f32_16x16x32_bf16 v[20:23], v[252:255], v[164:167], v[20:23]
    v_rcp_f32 v242, v242
    v_rcp_f32 v243, v243
    v_mfma_f32_16x16x32_bf16 v[20:23], v[236:239], v[160:163], v[20:23]
    v_rcp_f32 v244, v244
    v_rcp_f32 v245, v245
    v_mfma_f32_16x16x32_bf16 v[20:23], v[232:235], v[156:159], v[20:23]
    v_rcp_f32 v246, v246
    v_rcp_f32 v247, v247
    v_rcp_f32 v248, v248
    v_rcp_f32 v249, v249
    v_pk_mul_f32 v[242:243], v[8:9], v[242:243]
    v_pk_mul_f32 v[244:245], v[10:11], v[244:245]
    v_pk_mul_f32 v[246:247], v[24:25], v[246:247]
    v_pk_mul_f32 v[248:249], v[26:27], v[248:249]
    v_cvt_pk_bf16_f32 v8, v242, v243
    v_cvt_pk_bf16_f32 v10, v246, v247
    v_cvt_pk_bf16_f32 v9, v244, v245
    v_cvt_pk_bf16_f32 v11, v248, v249
    v_pk_fma_f32 v[12:13], v[12:13], v[228:229], v[200:201]
    v_pk_fma_f32 v[14:15], v[14:15], v[230:231], v[202:203]
    v_pk_fma_f32 v[28:29], v[28:29], v[196:197], v[192:193]
    v_pk_fma_f32 v[30:31], v[30:31], v[198:199], v[194:195]
    v_permlane16_swap_b32 v8, v10
    v_permlane16_swap_b32 v9, v11
    s_waitcnt lgkmcnt(0)
    v_mfma_f32_16x16x32_bf16 v[16:19], v[232:235], v[144:147], v[16:19]
    buffer_store_dwordx4 v[8:11], v251, s[28:31], s66 offen offset:0 sc1
    v_exp_f32_e64 v242, -v12
    v_exp_f32_e64 v243, -v13
    v_mfma_f32_16x16x32_bf16 v[16:19], v[236:239], v[148:151], v[16:19]
    ds_read_b64_tr_b16 v[24:25], v241 offset:20576
    v_exp_f32_e64 v244, -v14
    v_exp_f32_e64 v245, -v15
    v_mfma_f32_16x16x32_bf16 v[16:19], v[252:255], v[152:155], v[16:19]
    ds_read_b64_tr_b16 v[26:27], v241 offset:23136
    v_exp_f32_e64 v246, -v28
    v_exp_f32_e64 v247, -v29
    v_exp_f32_e64 v248, -v30
    v_exp_f32_e64 v249, -v31
    v_pk_fma_f32 v[242:243], v[242:243], s[58:59], s[58:59]
    v_pk_fma_f32 v[244:245], v[244:245], s[58:59], s[58:59]
    v_pk_fma_f32 v[246:247], v[246:247], s[58:59], s[58:59]
    v_pk_fma_f32 v[248:249], v[248:249], s[58:59], s[58:59]
    v_mfma_f32_16x16x32_bf16 v[0:3], v[224:227], v[152:155], v[0:3]
    ds_read_b64_tr_b16 v[232:233], v241 offset:10336
    v_rcp_f32 v242, v242
N_6:
    s_cbranch_execz L_tret
    v_rcp_f32 v243, v243
    v_mfma_f32_16x16x32_bf16 v[0:3], v[220:223], v[148:151], v[0:3]
    ds_read_b64_tr_b16 v[234:235], v241 offset:12896
    v_rcp_f32 v244, v244
    v_rcp_f32 v245, v245
    v_mfma_f32_16x16x32_bf16 v[0:3], v[216:219], v[144:147], v[0:3]
    ds_read_b64_tr_b16 v[236:237], v241 offset:96
    v_rcp_f32 v246, v246
    v_rcp_f32 v247, v247
    v_rcp_f32 v248, v248
    v_rcp_f32 v249, v249
    v_pk_mul_f32 v[242:243], v[12:13], v[242:243]
    v_pk_mul_f32 v[244:245], v[14:15], v[244:245]
    v_pk_mul_f32 v[246:247], v[28:29], v[246:247]
    v_pk_mul_f32 v[248:249], v[30:31], v[248:249]
    v_cvt_pk_bf16_f32 v12, v242, v243
    v_cvt_pk_bf16_f32 v14, v246, v247
    v_cvt_pk_bf16_f32 v13, v244, v245
    v_cvt_pk_bf16_f32 v15, v248, v249
    v_pk_fma_f32 v[4:5], v[4:5], v[228:229], v[200:201]
    v_pk_fma_f32 v[6:7], v[6:7], v[230:231], v[202:203]
    v_pk_fma_f32 v[20:21], v[20:21], v[196:197], v[192:193]
    v_pk_fma_f32 v[22:23], v[22:23], v[198:199], v[194:195]
    v_permlane16_swap_b32 v12, v14
    v_permlane16_swap_b32 v13, v15
    v_mfma_f32_16x16x32_bf16 v[32:35], v[212:215], v[144:147], v[32:35]
    buffer_store_dwordx4 v[12:15], v251, s[28:31], s67 offen offset:0 sc1
    v_exp_f32_e64 v242, -v4
    v_exp_f32_e64 v243, -v5
    v_mfma_f32_16x16x32_bf16 v[32:35], v[208:211], v[148:151], v[32:35]
    ds_read_b64_tr_b16 v[238:239], v241 offset:2656
    v_exp_f32_e64 v244, -v6
    v_exp_f32_e64 v245, -v7
    v_mfma_f32_16x16x32_bf16 v[32:35], v[204:207], v[152:155], v[32:35]
    ds_read_b128 v[252:255], v250 offset:256
    v_exp_f32_e64 v246, -v20
    v_exp_f32_e64 v247, -v21
    v_exp_f32_e64 v248, -v22
    v_exp_f32_e64 v249, -v23
    v_pk_fma_f32 v[242:243], v[242:243], s[58:59], s[58:59]
    v_pk_fma_f32 v[244:245], v[244:245], s[58:59], s[58:59]
    v_pk_fma_f32 v[246:247], v[246:247], s[58:59], s[58:59]
    v_pk_fma_f32 v[248:249], v[248:249], s[58:59], s[58:59]
    s_waitcnt lgkmcnt(2)
    v_mfma_f32_16x16x32_bf16 v[48:51], v[24:27], v[152:155], v[48:51]
    ds_read_b128 v[224:227], v250 offset:320
    v_rcp_f32 v242, v242
    v_rcp_f32 v243, v243
    v_mfma_f32_16x16x32_bf16 v[48:51], v[232:235], v[148:151], v[48:51]
    ds_read_b128 v[220:223], v250 offset:384
    v_rcp_f32 v244, v244
    v_rcp_f32 v245, v245
    s_waitcnt lgkmcnt(3)
    v_mfma_f32_16x16x32_bf16 v[48:51], v[236:239], v[144:147], v[48:51]
    ds_read_b128 v[216:219], v250 offset:448
    v_rcp_f32 v246, v246
    v_rcp_f32 v247, v247
    v_rcp_f32 v248, v248
    v_rcp_f32 v249, v249
    v_pk_mul_f32 v[242:243], v[4:5], v[242:243]
    v_pk_mul_f32 v[244:245], v[6:7], v[244:245]
    v_pk_mul_f32 v[246:247], v[20:21], v[246:247]
    v_pk_mul_f32 v[248:249], v[22:23], v[248:249]
    v_cvt_pk_bf16_f32 v4, v242, v243
    v_cvt_pk_bf16_f32 v6, v246, v247
    v_cvt_pk_bf16_f32 v5, v244, v245
    v_cvt_pk_bf16_f32 v7, v248, v249
    v_pk_fma_f32 v[0:1], v[0:1], v[228:229], v[200:201]
    v_pk_fma_f32 v[2:3], v[2:3], v[230:231], v[202:203]
    v_pk_fma_f32 v[16:17], v[16:17], v[196:197], v[192:193]
    v_pk_fma_f32 v[18:19], v[18:19], v[198:199], v[194:195]
    v_permlane16_swap_b32 v4, v6
    v_permlane16_swap_b32 v5, v7
    v_mfma_f32_16x16x32_bf16 v[52:55], v[236:239], v[156:159], v[52:55]
    buffer_store_dwordx4 v[4:7], v251, s[28:31], s65 offen offset:0 sc1
    v_exp_f32_e64 v242, -v0
    v_exp_f32_e64 v243, -v1
    v_mfma_f32_16x16x32_bf16 v[52:55], v[232:235], v[160:163], v[52:55]
    ds_read_b64_tr_b16 v[28:29], v240 offset:128
    v_exp_f32_e64 v244, -v2
    v_exp_f32_e64 v245, -v3
    v_mfma_f32_16x16x32_bf16 v[52:55], v[24:27], v[164:167], v[52:55]
    ds_read_b64_tr_b16 v[30:31], v240 offset:2688
    v_exp_f32_e64 v246, -v16
    v_exp_f32_e64 v247, -v17
    v_exp_f32_e64 v248, -v18
    v_exp_f32_e64 v249, -v19
    v_pk_fma_f32 v[242:243], v[242:243], s[58:59], s[58:59]
    v_pk_fma_f32 v[244:245], v[244:245], s[58:59], s[58:59]
    v_pk_fma_f32 v[246:247], v[246:247], s[58:59], s[58:59]
    v_pk_fma_f32 v[248:249], v[248:249], s[58:59], s[58:59]
    v_mfma_f32_16x16x32_bf16 v[36:39], v[204:207], v[164:167], v[36:39]
    ds_read_b64_tr_b16 v[20:21], v240 offset:10368
    v_rcp_f32 v242, v242
    v_rcp_f32 v243, v243
    v_mfma_f32_16x16x32_bf16 v[36:39], v[208:211], v[160:163], v[36:39]
    ds_read_b64_tr_b16 v[22:23], v240 offset:12928
    v_rcp_f32 v244, v244
    v_rcp_f32 v245, v245
    v_mfma_f32_16x16x32_bf16 v[36:39], v[212:215], v[156:159], v[36:39]
    ds_read_b64_tr_b16 v[228:229], v240 offset:20608
    v_rcp_f32 v246, v246
    v_rcp_f32 v247, v247
    v_rcp_f32 v248, v248
    v_rcp_f32 v249, v249
    v_pk_mul_f32 v[242:243], v[0:1], v[242:243]
    v_pk_mul_f32 v[244:245], v[2:3], v[244:245]
    v_pk_mul_f32 v[246:247], v[16:17], v[246:247]
    v_pk_mul_f32 v[248:249], v[18:19], v[248:249]
    v_cvt_pk_bf16_f32 v0, v242, v243
    v_cvt_pk_bf16_f32 v2, v246, v247
    v_cvt_pk_bf16_f32 v1, v244, v245
    v_cvt_pk_bf16_f32 v3, v248, v249
    s_waitcnt lgkmcnt(3)
    v_pk_fma_f32 v[32:33], v[32:33], v[252:253], v[224:225]
    v_pk_fma_f32 v[34:35], v[34:35], v[254:255], v[226:227]
    v_pk_fma_f32 v[48:49], v[48:49], v[220:221], v[216:217]
    v_pk_fma_f32 v[50:51], v[50:51], v[222:223], v[218:219]
    v_permlane16_swap_b32 v0, v2
    v_permlane16_swap_b32 v1, v3
    v_mfma_f32_16x16x32_bf16 v[40:43], v[212:215], v[168:171], v[40:43]
    buffer_store_dwordx4 v[0:3], v251, s[28:31], s64 offen offset:0 sc1
    v_exp_f32_e64 v242, -v32
    v_exp_f32_e64 v243, -v33
    v_mfma_f32_16x16x32_bf16 v[40:43], v[208:211], v[172:175], v[40:43]
    ds_read_b64_tr_b16 v[230:231], v240 offset:23168
    v_exp_f32_e64 v244, -v34
    v_exp_f32_e64 v245, -v35
    v_mfma_f32_16x16x32_bf16 v[40:43], v[204:207], v[176:179], v[40:43]
    ds_read_b64_tr_b16 v[200:201], v241 offset:20640
    v_exp_f32_e64 v246, -v48
    v_exp_f32_e64 v247, -v49
    v_exp_f32_e64 v248, -v50
    v_exp_f32_e64 v249, -v51
    v_pk_fma_f32 v[242:243], v[242:243], s[58:59], s[58:59]
    v_pk_fma_f32 v[244:245], v[244:245], s[58:59], s[58:59]
    v_pk_fma_f32 v[246:247], v[246:247], s[58:59], s[58:59]
    v_pk_fma_f32 v[248:249], v[248:249], s[58:59], s[58:59]
    v_mfma_f32_16x16x32_bf16 v[56:59], v[24:27], v[176:179], v[56:59]
    ds_read_b64_tr_b16 v[202:203], v241 offset:23200
    v_rcp_f32 v242, v242
    v_rcp_f32 v243, v243
    v_mfma_f32_16x16x32_bf16 v[56:59], v[232:235], v[172:175], v[56:59]
    ds_read_b64_tr_b16 v[196:197], v241 offset:10400
    v_rcp_f32 v244, v244
N_7:
    s_cbranch_execz L_tret
    v_rcp_f32 v245, v245
    v_mfma_f32_16x16x32_bf16 v[56:59], v[236:239], v[168:171], v[56:59]
    ds_read_b64_tr_b16 v[198:199], v241 offset:12960
    v_rcp_f32 v246, v246
    v_rcp_f32 v247, v247
    v_rcp_f32 v248, v248
    v_rcp_f32 v249, v249
    v_pk_mul_f32 v[242:243], v[32:33], v[242:243]
    v_pk_mul_f32 v[244:245], v[34:35], v[244:245]
    v_pk_mul_f32 v[246:247], v[48:49], v[246:247]
    v_pk_mul_f32 v[248:249], v[50:51], v[248:249]
    v_cvt_pk_bf16_f32 v32, v242, v243
    v_cvt_pk_bf16_f32 v34, v246, v247
    v_cvt_pk_bf16_f32 v33, v244, v245
    v_cvt_pk_bf16_f32 v35, v248, v249
    v_pk_fma_f32 v[36:37], v[36:37], v[252:253], v[224:225]
    v_pk_fma_f32 v[38:39], v[38:39], v[254:255], v[226:227]
    v_pk_fma_f32 v[52:53], v[52:53], v[220:221], v[216:217]
    v_pk_fma_f32 v[54:55], v[54:55], v[222:223], v[218:219]
    v_permlane16_swap_b32 v32, v34
    v_permlane16_swap_b32 v33, v35
    v_mfma_f32_16x16x32_bf16 v[60:63], v[236:239], v[180:183], v[60:63]
    buffer_store_dwordx4 v[32:35], v251, s[28:31], s64 offen offset:64 sc1
    v_exp_f32_e64 v242, -v36
    v_exp_f32_e64 v243, -v37
    v_mfma_f32_16x16x32_bf16 v[60:63], v[232:235], v[184:187], v[60:63]
    ds_read_b64_tr_b16 v[192:193], v241 offset:160
    v_exp_f32_e64 v244, -v38
    v_exp_f32_e64 v245, -v39
    v_mfma_f32_16x16x32_bf16 v[60:63], v[24:27], v[188:191], v[60:63]
    ds_read_b64_tr_b16 v[194:195], v241 offset:2720
    v_exp_f32_e64 v246, -v52
    v_exp_f32_e64 v247, -v53
    v_exp_f32_e64 v248, -v54
    v_exp_f32_e64 v249, -v55
    v_pk_fma_f32 v[242:243], v[242:243], s[58:59], s[58:59]
    v_pk_fma_f32 v[244:245], v[244:245], s[58:59], s[58:59]
    v_pk_fma_f32 v[246:247], v[246:247], s[58:59], s[58:59]
    v_pk_fma_f32 v[248:249], v[248:249], s[58:59], s[58:59]
    v_mfma_f32_16x16x32_bf16 v[44:47], v[204:207], v[188:191], v[44:47]
    ds_read_b128 v[16:19], v250 offset:512
    v_rcp_f32 v242, v242
    v_rcp_f32 v243, v243
    v_mfma_f32_16x16x32_bf16 v[44:47], v[208:211], v[184:187], v[44:47]
    ds_read_b128 v[48:51], v250 offset:576
    v_rcp_f32 v244, v244
    v_rcp_f32 v245, v245
    v_mfma_f32_16x16x32_bf16 v[44:47], v[212:215], v[180:183], v[44:47]
    ds_read_b128 v[236:239], v250 offset:640
    v_rcp_f32 v246, v246
    v_rcp_f32 v247, v247
    v_rcp_f32 v248, v248
    v_rcp_f32 v249, v249
    v_pk_mul_f32 v[242:243], v[36:37], v[242:243]
    v_pk_mul_f32 v[244:245], v[38:39], v[244:245]
    v_pk_mul_f32 v[246:247], v[52:53], v[246:247]
    v_pk_mul_f32 v[248:249], v[54:55], v[248:249]
    v_cvt_pk_bf16_f32 v36, v242, v243
    v_cvt_pk_bf16_f32 v38, v246, v247
    v_cvt_pk_bf16_f32 v37, v244, v245
    v_cvt_pk_bf16_f32 v39, v248, v249
    v_pk_fma_f32 v[40:41], v[40:41], v[252:253], v[224:225]
    v_pk_fma_f32 v[42:43], v[42:43], v[254:255], v[226:227]
    v_pk_fma_f32 v[56:57], v[56:57], v[220:221], v[216:217]
    v_pk_fma_f32 v[58:59], v[58:59], v[222:223], v[218:219]
    v_permlane16_swap_b32 v36, v38
    v_permlane16_swap_b32 v37, v39
    v_mfma_f32_16x16x32_bf16 v[76:79], v[28:31], v[180:183], v[76:79]
    buffer_store_dwordx4 v[36:39], v251, s[28:31], s65 offen offset:64 sc1
    v_exp_f32_e64 v242, -v40
    v_exp_f32_e64 v243, -v41
    s_waitcnt lgkmcnt(2)
    v_mfma_f32_16x16x32_bf16 v[76:79], v[20:23], v[184:187], v[76:79]
    ds_read_b128 v[232:235], v250 offset:704
    v_exp_f32_e64 v244, -v42
    v_exp_f32_e64 v245, -v43
    v_mfma_f32_16x16x32_bf16 v[76:79], v[228:231], v[188:191], v[76:79]
    ds_read_b64_tr_b16 v[24:25], v240 offset:192
    v_exp_f32_e64 v246, -v56
    v_exp_f32_e64 v247, -v57
    v_exp_f32_e64 v248, -v58
    v_exp_f32_e64 v249, -v59
    v_pk_fma_f32 v[242:243], v[242:243], s[58:59], s[58:59]
    v_pk_fma_f32 v[244:245], v[244:245], s[58:59], s[58:59]
    v_pk_fma_f32 v[246:247], v[246:247], s[58:59], s[58:59]
    v_pk_fma_f32 v[248:249], v[248:249], s[58:59], s[58:59]
    v_mfma_f32_16x16x32_bf16 v[92:95], v[200:203], v[188:191], v[92:95]
    ds_read_b64_tr_b16 v[26:27], v240 offset:2752
    v_rcp_f32 v242, v242
    v_rcp_f32 v243, v243
    v_mfma_f32_16x16x32_bf16 v[92:95], v[196:199], v[184:187], v[92:95]
    ds_read_b64_tr_b16 v[204:205], v240 offset:10432
    v_rcp_f32 v244, v244
    v_rcp_f32 v245, v245
    v_mfma_f32_16x16x32_bf16 v[92:95], v[192:195], v[180:183], v[92:95]
    ds_read_b64_tr_b16 v[206:207], v240 offset:12992
    v_rcp_f32 v246, v246
    v_rcp_f32 v247, v247
    v_rcp_f32 v248, v248
    v_rcp_f32 v249, v249
    v_pk_mul_f32 v[242:243], v[40:41], v[242:243]
    v_pk_mul_f32 v[244:245], v[42:43], v[244:245]
    v_pk_mul_f32 v[246:247], v[56:57], v[246:247]
    v_pk_mul_f32 v[248:249], v[58:59], v[248:249]
    v_cvt_pk_bf16_f32 v40, v242, v243
    v_cvt_pk_bf16_f32 v42, v246, v247
    v_cvt_pk_bf16_f32 v41, v244, v245
    v_cvt_pk_bf16_f32 v43, v248, v249
    v_pk_fma_f32 v[44:45], v[44:45], v[252:253], v[224:225]
    v_pk_fma_f32 v[46:47], v[46:47], v[254:255], v[226:227]
    v_pk_fma_f32 v[60:61], v[60:61], v[220:221], v[216:217]
    v_pk_fma_f32 v[62:63], v[62:63], v[222:223], v[218:219]
    v_permlane16_swap_b32 v40, v42
    v_permlane16_swap_b32 v41, v43
    v_mfma_f32_16x16x32_bf16 v[88:91], v[192:195], v[168:171], v[88:91]
    buffer_store_dwordx4 v[40:43], v251, s[28:31], s66 offen offset:64 sc1
    v_exp_f32_e64 v242, -v44
    v_exp_f32_e64 v243, -v45
    v_mfma_f32_16x16x32_bf16 v[88:91], v[196:199], v[172:175], v[88:91]
    ds_read_b64_tr_b16 v[208:209], v240 offset:20672
    v_exp_f32_e64 v244, -v46
    v_exp_f32_e64 v245, -v47
    v_mfma_f32_16x16x32_bf16 v[88:91], v[200:203], v[176:179], v[88:91]
    ds_read_b64_tr_b16 v[210:211], v240 offset:23232
    v_exp_f32_e64 v246, -v60
    v_exp_f32_e64 v247, -v61
    v_exp_f32_e64 v248, -v62
    v_exp_f32_e64 v249, -v63
    v_pk_fma_f32 v[242:243], v[242:243], s[58:59], s[58:59]
    v_pk_fma_f32 v[244:245], v[244:245], s[58:59], s[58:59]
    v_pk_fma_f32 v[246:247], v[246:247], s[58:59], s[58:59]
    v_pk_fma_f32 v[248:249], v[248:249], s[58:59], s[58:59]
    v_mfma_f32_16x16x32_bf16 v[72:75], v[228:231], v[176:179], v[72:75]
    ds_read_b64_tr_b16 v[212:213], v241 offset:20704
    v_rcp_f32 v242, v242
    v_rcp_f32 v243, v243
    v_mfma_f32_16x16x32_bf16 v[72:75], v[20:23], v[172:175], v[72:75]
    ds_read_b64_tr_b16 v[214:215], v241 offset:23264
    v_rcp_f32 v244, v244
    v_rcp_f32 v245, v245
    v_mfma_f32_16x16x32_bf16 v[72:75], v[28:31], v[168:171], v[72:75]
    ds_read_b64_tr_b16 v[52:53], v241 offset:10464
    v_rcp_f32 v246, v246
N_8:
    s_cbranch_execz L_tret
    v_rcp_f32 v247, v247
    v_rcp_f32 v248, v248
    v_rcp_f32 v249, v249
    v_pk_mul_f32 v[242:243], v[44:45], v[242:243]
    v_pk_mul_f32 v[244:245], v[46:47], v[244:245]
    v_pk_mul_f32 v[246:247], v[60:61], v[246:247]
    v_pk_mul_f32 v[248:249], v[62:63], v[248:249]
    v_cvt_pk_bf16_f32 v44, v242, v243
    v_cvt_pk_bf16_f32 v46, v246, v247
    v_cvt_pk_bf16_f32 v45, v244, v245
    v_cvt_pk_bf16_f32 v47, v248, v249
    s_waitcnt lgkmcnt(3)
    v_pk_fma_f32 v[76:77], v[76:77], v[16:17], v[48:49]
    v_pk_fma_f32 v[78:79], v[78:79], v[18:19], v[50:51]
    v_pk_fma_f32 v[92:93], v[92:93], v[236:237], v[232:233]
    v_pk_fma_f32 v[94:95], v[94:95], v[238:239], v[234:235]
    v_permlane16_swap_b32 v44, v46
    v_permlane16_swap_b32 v45, v47
    v_mfma_f32_16x16x32_bf16 v[68:71], v[28:31], v[156:159], v[68:71]
    buffer_store_dwordx4 v[44:47], v251, s[28:31], s67 offen offset:64 sc1
    v_exp_f32_e64 v242, -v76
    v_exp_f32_e64 v243, -v77
    v_mfma_f32_16x16x32_bf16 v[68:71], v[20:23], v[160:163], v[68:71]
    ds_read_b64_tr_b16 v[54:55], v241 offset:13024
    v_exp_f32_e64 v244, -v78
    v_exp_f32_e64 v245, -v79
    v_mfma_f32_16x16x32_bf16 v[68:71], v[228:231], v[164:167], v[68:71]
    ds_read_b64_tr_b16 v[56:57], v241 offset:224
    v_exp_f32_e64 v246, -v92
    v_exp_f32_e64 v247, -v93
    v_exp_f32_e64 v248, -v94
    v_exp_f32_e64 v249, -v95
    v_pk_fma_f32 v[242:243], v[242:243], s[58:59], s[58:59]
    v_pk_fma_f32 v[244:245], v[244:245], s[58:59], s[58:59]
    v_pk_fma_f32 v[246:247], v[246:247], s[58:59], s[58:59]
    v_pk_fma_f32 v[248:249], v[248:249], s[58:59], s[58:59]
    v_mfma_f32_16x16x32_bf16 v[84:87], v[200:203], v[164:167], v[84:87]
    ds_read_b64_tr_b16 v[58:59], v241 offset:2784
    v_rcp_f32 v242, v242
    v_rcp_f32 v243, v243
    v_mfma_f32_16x16x32_bf16 v[84:87], v[196:199], v[160:163], v[84:87]
    ds_read_b128 v[252:255], v250 offset:768
    v_rcp_f32 v244, v244
    v_rcp_f32 v245, v245
    v_mfma_f32_16x16x32_bf16 v[84:87], v[192:195], v[156:159], v[84:87]
    ds_read_b128 v[224:227], v250 offset:832
    v_rcp_f32 v246, v246
    v_rcp_f32 v247, v247
    v_rcp_f32 v248, v248
    v_rcp_f32 v249, v249
    v_pk_mul_f32 v[242:243], v[76:77], v[242:243]
    v_pk_mul_f32 v[244:245], v[78:79], v[244:245]
    v_pk_mul_f32 v[246:247], v[92:93], v[246:247]
    v_pk_mul_f32 v[248:249], v[94:95], v[248:249]
    v_cvt_pk_bf16_f32 v76, v242, v243
    v_cvt_pk_bf16_f32 v78, v246, v247
    v_cvt_pk_bf16_f32 v77, v244, v245
    v_cvt_pk_bf16_f32 v79, v248, v249
    v_pk_fma_f32 v[72:73], v[72:73], v[16:17], v[48:49]
    v_pk_fma_f32 v[74:75], v[74:75], v[18:19], v[50:51]
    v_pk_fma_f32 v[88:89], v[88:89], v[236:237], v[232:233]
    v_pk_fma_f32 v[90:91], v[90:91], v[238:239], v[234:235]
    v_permlane16_swap_b32 v76, v78
    v_permlane16_swap_b32 v77, v79
    v_mfma_f32_16x16x32_bf16 v[80:83], v[192:195], v[144:147], v[80:83]
    buffer_store_dwordx4 v[76:79], v251, s[28:31], s67 offen offset:128 sc1
    v_exp_f32_e64 v242, -v72
    v_exp_f32_e64 v243, -v73
    v_mfma_f32_16x16x32_bf16 v[80:83], v[196:199], v[148:151], v[80:83]
    ds_read_b128 v[220:223], v250 offset:896
    v_exp_f32_e64 v244, -v74
    v_exp_f32_e64 v245, -v75
    v_mfma_f32_16x16x32_bf16 v[80:83], v[200:203], v[152:155], v[80:83]
    ds_read_b128 v[216:219], v250 offset:960
    v_exp_f32_e64 v246, -v88
    v_exp_f32_e64 v247, -v89
    v_exp_f32_e64 v248, -v90
    v_exp_f32_e64 v249, -v91
    v_pk_fma_f32 v[242:243], v[242:243], s[58:59], s[58:59]
    v_pk_fma_f32 v[244:245], v[244:245], s[58:59], s[58:59]
    v_pk_fma_f32 v[246:247], v[246:247], s[58:59], s[58:59]
    v_pk_fma_f32 v[248:249], v[248:249], s[58:59], s[58:59]
    v_mfma_f32_16x16x32_bf16 v[64:67], v[228:231], v[152:155], v[64:67]
    ds_read_b64_tr_b16 v[60:61], v240 offset:256
    v_rcp_f32 v242, v242
    v_rcp_f32 v243, v243
    v_mfma_f32_16x16x32_bf16 v[64:67], v[20:23], v[148:151], v[64:67]
    ds_read_b64_tr_b16 v[62:63], v240 offset:2816
    v_rcp_f32 v244, v244
    v_rcp_f32 v245, v245
    v_mfma_f32_16x16x32_bf16 v[64:67], v[28:31], v[144:147], v[64:67]
    ds_read_b64_tr_b16 v[92:93], v240 offset:10496
    v_rcp_f32 v246, v246
    v_rcp_f32 v247, v247
    v_rcp_f32 v248, v248
    v_rcp_f32 v249, v249
    v_pk_mul_f32 v[242:243], v[72:73], v[242:243]
    v_pk_mul_f32 v[244:245], v[74:75], v[244:245]
    v_pk_mul_f32 v[246:247], v[88:89], v[246:247]
    v_pk_mul_f32 v[248:249], v[90:91], v[248:249]
    v_cvt_pk_bf16_f32 v72, v242, v243
    v_cvt_pk_bf16_f32 v74, v246, v247
    v_cvt_pk_bf16_f32 v73, v244, v245
    v_cvt_pk_bf16_f32 v75, v248, v249
    v_pk_fma_f32 v[68:69], v[68:69], v[16:17], v[48:49]
    v_pk_fma_f32 v[70:71], v[70:71], v[18:19], v[50:51]
    v_pk_fma_f32 v[84:85], v[84:85], v[236:237], v[232:233]
    v_pk_fma_f32 v[86:87], v[86:87], v[238:239], v[234:235]
    v_permlane16_swap_b32 v72, v74
    v_permlane16_swap_b32 v73, v75
    v_mfma_f32_16x16x32_bf16 v[96:99], v[24:27], v[144:147], v[96:99]
    buffer_store_dwordx4 v[72:75], v251, s[28:31], s66 offen offset:128 sc1
    v_exp_f32_e64 v242, -v68
    v_exp_f32_e64 v243, -v69
    v_mfma_f32_16x16x32_bf16 v[96:99], v[204:207], v[148:151], v[96:99]
    ds_read_b64_tr_b16 v[94:95], v240 offset:13056
    v_exp_f32_e64 v244, -v70
    v_exp_f32_e64 v245, -v71
    v_mfma_f32_16x16x32_bf16 v[96:99], v[208:211], v[152:155], v[96:99]
    ds_read_b64_tr_b16 v[192:193], v240 offset:20736
    v_exp_f32_e64 v246, -v84
    v_exp_f32_e64 v247, -v85
    v_exp_f32_e64 v248, -v86
    v_exp_f32_e64 v249, -v87
    v_pk_fma_f32 v[242:243], v[242:243], s[58:59], s[58:59]
    v_pk_fma_f32 v[244:245], v[244:245], s[58:59], s[58:59]
    v_pk_fma_f32 v[246:247], v[246:247], s[58:59], s[58:59]
    v_pk_fma_f32 v[248:249], v[248:249], s[58:59], s[58:59]
    s_waitcnt lgkmcnt(2)
    v_mfma_f32_16x16x32_bf16 v[112:115], v[212:215], v[152:155], v[112:115]
    ds_read_b64_tr_b16 v[194:195], v240 offset:23296
    v_rcp_f32 v242, v242
    v_rcp_f32 v243, v243
    v_mfma_f32_16x16x32_bf16 v[112:115], v[52:55], v[148:151], v[112:115]
    ds_read_b64_tr_b16 v[196:197], v241 offset:20768
    v_rcp_f32 v244, v244
    v_rcp_f32 v245, v245
    v_mfma_f32_16x16x32_bf16 v[112:115], v[56:59], v[144:147], v[112:115]
    ds_read_b64_tr_b16 v[198:199], v241 offset:23328
    v_rcp_f32 v246, v246
    v_rcp_f32 v247, v247
    v_rcp_f32 v248, v248
    v_rcp_f32 v249, v249
    v_pk_mul_f32 v[242:243], v[68:69], v[242:243]
    v_pk_mul_f32 v[244:245], v[70:71], v[244:245]
N_9:
    s_cbranch_execz L_tret
    v_pk_mul_f32 v[246:247], v[84:85], v[246:247]
    v_pk_mul_f32 v[248:249], v[86:87], v[248:249]
    v_cvt_pk_bf16_f32 v68, v242, v243
    v_cvt_pk_bf16_f32 v70, v246, v247
    v_cvt_pk_bf16_f32 v69, v244, v245
    v_cvt_pk_bf16_f32 v71, v248, v249
    v_pk_fma_f32 v[64:65], v[64:65], v[16:17], v[48:49]
    v_pk_fma_f32 v[66:67], v[66:67], v[18:19], v[50:51]
    v_pk_fma_f32 v[80:81], v[80:81], v[236:237], v[232:233]
    v_pk_fma_f32 v[82:83], v[82:83], v[238:239], v[234:235]
    v_permlane16_swap_b32 v68, v70
    v_permlane16_swap_b32 v69, v71
    v_mfma_f32_16x16x32_bf16 v[116:119], v[56:59], v[156:159], v[116:119]
    buffer_store_dwordx4 v[68:71], v251, s[28:31], s65 offen offset:128 sc1
    v_exp_f32_e64 v242, -v64
    v_exp_f32_e64 v243, -v65
    v_mfma_f32_16x16x32_bf16 v[116:119], v[52:55], v[160:163], v[116:119]
    ds_read_b64_tr_b16 v[200:201], v241 offset:10528
    v_exp_f32_e64 v244, -v66
    v_exp_f32_e64 v245, -v67
    v_mfma_f32_16x16x32_bf16 v[116:119], v[212:215], v[164:167], v[116:119]
    ds_read_b64_tr_b16 v[202:203], v241 offset:13088
    v_exp_f32_e64 v246, -v80
    v_exp_f32_e64 v247, -v81
    v_exp_f32_e64 v248, -v82
    v_exp_f32_e64 v249, -v83
    v_pk_fma_f32 v[242:243], v[242:243], s[58:59], s[58:59]
    v_pk_fma_f32 v[244:245], v[244:245], s[58:59], s[58:59]
    v_pk_fma_f32 v[246:247], v[246:247], s[58:59], s[58:59]
    v_pk_fma_f32 v[248:249], v[248:249], s[58:59], s[58:59]
    v_mfma_f32_16x16x32_bf16 v[100:103], v[208:211], v[164:167], v[100:103]
    ds_read_b64_tr_b16 v[228:229], v241 offset:288
    v_rcp_f32 v242, v242
    v_rcp_f32 v243, v243
    v_mfma_f32_16x16x32_bf16 v[100:103], v[204:207], v[160:163], v[100:103]
    ds_read_b64_tr_b16 v[230:231], v241 offset:2848
    v_rcp_f32 v244, v244
    v_rcp_f32 v245, v245
    v_mfma_f32_16x16x32_bf16 v[100:103], v[24:27], v[156:159], v[100:103]
    ds_read_b128 v[20:23], v250 offset:1024
    v_rcp_f32 v246, v246
    v_rcp_f32 v247, v247
    v_rcp_f32 v248, v248
    v_rcp_f32 v249, v249
    v_pk_mul_f32 v[242:243], v[64:65], v[242:243]
    v_pk_mul_f32 v[244:245], v[66:67], v[244:245]
    v_pk_mul_f32 v[246:247], v[80:81], v[246:247]
    v_pk_mul_f32 v[248:249], v[82:83], v[248:249]
    v_cvt_pk_bf16_f32 v64, v242, v243
    v_cvt_pk_bf16_f32 v66, v246, v247
    v_cvt_pk_bf16_f32 v65, v244, v245
    v_cvt_pk_bf16_f32 v67, v248, v249
    v_pk_fma_f32 v[96:97], v[96:97], v[252:253], v[224:225]
    v_pk_fma_f32 v[98:99], v[98:99], v[254:255], v[226:227]
    v_pk_fma_f32 v[112:113], v[112:113], v[220:221], v[216:217]
    v_pk_fma_f32 v[114:115], v[114:115], v[222:223], v[218:219]
    v_permlane16_swap_b32 v64, v66
    v_permlane16_swap_b32 v65, v67
    v_mfma_f32_16x16x32_bf16 v[104:107], v[24:27], v[168:171], v[104:107]
    buffer_store_dwordx4 v[64:67], v251, s[28:31], s64 offen offset:128 sc1
    v_exp_f32_e64 v242, -v96
    v_exp_f32_e64 v243, -v97
    v_mfma_f32_16x16x32_bf16 v[104:107], v[204:207], v[172:175], v[104:107]
    ds_read_b128 v[28:31], v250 offset:1088
    v_exp_f32_e64 v244, -v98
    v_exp_f32_e64 v245, -v99
    v_mfma_f32_16x16x32_bf16 v[104:107], v[208:211], v[176:179], v[104:107]
    ds_read_b128 v[88:91], v250 offset:1152
    v_exp_f32_e64 v246, -v112
    v_exp_f32_e64 v247, -v113
    v_exp_f32_e64 v248, -v114
    v_exp_f32_e64 v249, -v115
    v_pk_fma_f32 v[242:243], v[242:243], s[58:59], s[58:59]
    v_pk_fma_f32 v[244:245], v[244:245], s[58:59], s[58:59]
    v_pk_fma_f32 v[246:247], v[246:247], s[58:59], s[58:59]
    v_pk_fma_f32 v[248:249], v[248:249], s[58:59], s[58:59]
    v_mfma_f32_16x16x32_bf16 v[120:123], v[212:215], v[176:179], v[120:123]
    ds_read_b128 v[84:87], v250 offset:1216
    v_rcp_f32 v242, v242
    v_rcp_f32 v243, v243
    v_mfma_f32_16x16x32_bf16 v[120:123], v[52:55], v[172:175], v[120:123]
    v_rcp_f32 v244, v244
    v_rcp_f32 v245, v245
    v_mfma_f32_16x16x32_bf16 v[120:123], v[56:59], v[168:171], v[120:123]
    v_rcp_f32 v246, v246
    v_rcp_f32 v247, v247
    v_rcp_f32 v248, v248
    v_rcp_f32 v249, v249
    v_pk_mul_f32 v[242:243], v[96:97], v[242:243]
    v_pk_mul_f32 v[244:245], v[98:99], v[244:245]
    v_pk_mul_f32 v[246:247], v[112:113], v[246:247]
    v_pk_mul_f32 v[248:249], v[114:115], v[248:249]
    v_cvt_pk_bf16_f32 v96, v242, v243
    v_cvt_pk_bf16_f32 v98, v246, v247
    v_cvt_pk_bf16_f32 v97, v244, v245
    v_cvt_pk_bf16_f32 v99, v248, v249
    v_pk_fma_f32 v[100:101], v[100:101], v[252:253], v[224:225]
    v_pk_fma_f32 v[102:103], v[102:103], v[254:255], v[226:227]
    v_pk_fma_f32 v[116:117], v[116:117], v[220:221], v[216:217]
    v_pk_fma_f32 v[118:119], v[118:119], v[222:223], v[218:219]
    v_permlane16_swap_b32 v96, v98
    v_permlane16_swap_b32 v97, v99
    v_mfma_f32_16x16x32_bf16 v[124:127], v[56:59], v[180:183], v[124:127]
    buffer_store_dwordx4 v[96:99], v251, s[28:31], s64 offen offset:192 sc1
    v_exp_f32_e64 v242, -v100
    v_exp_f32_e64 v243, -v101
    v_mfma_f32_16x16x32_bf16 v[124:127], v[52:55], v[184:187], v[124:127]
    v_exp_f32_e64 v244, -v102
    v_exp_f32_e64 v245, -v103
    v_mfma_f32_16x16x32_bf16 v[124:127], v[212:215], v[188:191], v[124:127]
    v_exp_f32_e64 v246, -v116
    v_exp_f32_e64 v247, -v117
    v_exp_f32_e64 v248, -v118
    v_exp_f32_e64 v249, -v119
    v_pk_fma_f32 v[242:243], v[242:243], s[58:59], s[58:59]
    v_pk_fma_f32 v[244:245], v[244:245], s[58:59], s[58:59]
    v_pk_fma_f32 v[246:247], v[246:247], s[58:59], s[58:59]
    v_pk_fma_f32 v[248:249], v[248:249], s[58:59], s[58:59]
    v_mfma_f32_16x16x32_bf16 v[108:111], v[208:211], v[188:191], v[108:111]
    v_rcp_f32 v242, v242
    v_rcp_f32 v243, v243
    v_mfma_f32_16x16x32_bf16 v[108:111], v[204:207], v[184:187], v[108:111]
    v_rcp_f32 v244, v244
    v_rcp_f32 v245, v245
    v_mfma_f32_16x16x32_bf16 v[108:111], v[24:27], v[180:183], v[108:111]
    v_rcp_f32 v246, v246
    v_rcp_f32 v247, v247
    v_rcp_f32 v248, v248
    v_rcp_f32 v249, v249
    v_pk_mul_f32 v[242:243], v[100:101], v[242:243]
    v_pk_mul_f32 v[244:245], v[102:103], v[244:245]
    v_pk_mul_f32 v[246:247], v[116:117], v[246:247]
    v_pk_mul_f32 v[248:249], v[118:119], v[248:249]
    v_cvt_pk_bf16_f32 v100, v242, v243
    v_cvt_pk_bf16_f32 v102, v246, v247
    v_cvt_pk_bf16_f32 v101, v244, v245
    v_cvt_pk_bf16_f32 v103, v248, v249
    v_pk_fma_f32 v[104:105], v[104:105], v[252:253], v[224:225]
    v_pk_fma_f32 v[106:107], v[106:107], v[254:255], v[226:227]
    v_pk_fma_f32 v[120:121], v[120:121], v[220:221], v[216:217]
    v_pk_fma_f32 v[122:123], v[122:123], v[222:223], v[218:219]
    v_permlane16_swap_b32 v100, v102
    v_permlane16_swap_b32 v101, v103
    v_mfma_f32_16x16x32_bf16 v[132:135], v[60:63], v[156:159], v[132:135]
    buffer_store_dwordx4 v[100:103], v251, s[28:31], s65 offen offset:192 sc1
    v_exp_f32_e64 v242, -v104
N_10:
    s_cbranch_execz L_tret
    v_exp_f32_e64 v243, -v105
    s_waitcnt lgkmcnt(0)
    v_mfma_f32_16x16x32_bf16 v[132:135], v[92:95], v[160:163], v[132:135]
    v_exp_f32_e64 v244, -v106
    v_exp_f32_e64 v245, -v107
    v_mfma_f32_16x16x32_bf16 v[132:135], v[192:195], v[164:167], v[132:135]
    v_exp_f32_e64 v246, -v120
    v_exp_f32_e64 v247, -v121
    v_exp_f32_e64 v248, -v122
    v_exp_f32_e64 v249, -v123
    v_pk_fma_f32 v[242:243], v[242:243], s[58:59], s[58:59]
    v_pk_fma_f32 v[244:245], v[244:245], s[58:59], s[58:59]
    v_pk_fma_f32 v[246:247], v[246:247], s[58:59], s[58:59]
    v_pk_fma_f32 v[248:249], v[248:249], s[58:59], s[58:59]
    v_mfma_f32_16x16x32_bf16 v[140:143], v[196:199], v[164:167], v[140:143]
    v_rcp_f32 v242, v242
    v_rcp_f32 v243, v243
    v_mfma_f32_16x16x32_bf16 v[140:143], v[200:203], v[160:163], v[140:143]
    v_rcp_f32 v244, v244
    v_rcp_f32 v245, v245
    v_mfma_f32_16x16x32_bf16 v[140:143], v[228:231], v[156:159], v[140:143]
    v_rcp_f32 v246, v246
    v_rcp_f32 v247, v247
    v_rcp_f32 v248, v248
    v_rcp_f32 v249, v249
    v_pk_mul_f32 v[242:243], v[104:105], v[242:243]
    v_pk_mul_f32 v[244:245], v[106:107], v[244:245]
    v_pk_mul_f32 v[246:247], v[120:121], v[246:247]
    v_pk_mul_f32 v[248:249], v[122:123], v[248:249]
    v_cvt_pk_bf16_f32 v104, v242, v243
    v_cvt_pk_bf16_f32 v106, v246, v247
    v_cvt_pk_bf16_f32 v105, v244, v245
    v_cvt_pk_bf16_f32 v107, v248, v249
    v_pk_fma_f32 v[108:109], v[108:109], v[252:253], v[224:225]
    v_pk_fma_f32 v[110:111], v[110:111], v[254:255], v[226:227]
    v_pk_fma_f32 v[124:125], v[124:125], v[220:221], v[216:217]
    v_pk_fma_f32 v[126:127], v[126:127], v[222:223], v[218:219]
    v_permlane16_swap_b32 v104, v106
    v_permlane16_swap_b32 v105, v107
    v_mfma_f32_16x16x32_bf16 v[136:139], v[228:231], v[144:147], v[136:139]
    buffer_store_dwordx4 v[104:107], v251, s[28:31], s66 offen offset:192 sc1
    v_exp_f32_e64 v242, -v108
    v_exp_f32_e64 v243, -v109
    v_mfma_f32_16x16x32_bf16 v[136:139], v[200:203], v[148:151], v[136:139]
    v_exp_f32_e64 v244, -v110
    v_exp_f32_e64 v245, -v111
    v_mfma_f32_16x16x32_bf16 v[136:139], v[196:199], v[152:155], v[136:139]
    v_exp_f32_e64 v246, -v124
    v_exp_f32_e64 v247, -v125
    v_exp_f32_e64 v248, -v126
    v_exp_f32_e64 v249, -v127
    v_pk_fma_f32 v[242:243], v[242:243], s[58:59], s[58:59]
    v_pk_fma_f32 v[244:245], v[244:245], s[58:59], s[58:59]
    v_pk_fma_f32 v[246:247], v[246:247], s[58:59], s[58:59]
    v_pk_fma_f32 v[248:249], v[248:249], s[58:59], s[58:59]
    v_mfma_f32_16x16x32_bf16 v[128:131], v[192:195], v[152:155], v[128:131]
    v_rcp_f32 v242, v242
    v_rcp_f32 v243, v243
    v_mfma_f32_16x16x32_bf16 v[128:131], v[92:95], v[148:151], v[128:131]
    v_rcp_f32 v244, v244
    v_rcp_f32 v245, v245
    v_mfma_f32_16x16x32_bf16 v[128:131], v[60:63], v[144:147], v[128:131]
    v_rcp_f32 v246, v246
    v_rcp_f32 v247, v247
    v_rcp_f32 v248, v248
    v_rcp_f32 v249, v249
    v_pk_mul_f32 v[242:243], v[108:109], v[242:243]
    v_pk_mul_f32 v[244:245], v[110:111], v[244:245]
    v_pk_mul_f32 v[246:247], v[124:125], v[246:247]
    v_pk_mul_f32 v[248:249], v[126:127], v[248:249]
    v_cvt_pk_bf16_f32 v108, v242, v243
    v_cvt_pk_bf16_f32 v110, v246, v247
    v_cvt_pk_bf16_f32 v109, v244, v245
    v_cvt_pk_bf16_f32 v111, v248, v249
    v_pk_fma_f32 v[132:133], v[132:133], v[20:21], v[28:29]
    v_pk_fma_f32 v[134:135], v[134:135], v[22:23], v[30:31]
    v_pk_fma_f32 v[140:141], v[140:141], v[88:89], v[84:85]
    v_pk_fma_f32 v[142:143], v[142:143], v[90:91], v[86:87]
    v_permlane16_swap_b32 v108, v110
    v_permlane16_swap_b32 v109, v111
    buffer_store_dwordx4 v[108:111], v251, s[28:31], s67 offen offset:192 sc1
    v_exp_f32_e64 v242, -v132
    v_exp_f32_e64 v243, -v133
    v_exp_f32_e64 v244, -v134
    v_exp_f32_e64 v245, -v135
    v_exp_f32_e64 v246, -v140
    v_exp_f32_e64 v247, -v141
    v_exp_f32_e64 v248, -v142
    v_exp_f32_e64 v249, -v143
    v_pk_fma_f32 v[242:243], v[242:243], s[58:59], s[58:59]
    v_pk_fma_f32 v[244:245], v[244:245], s[58:59], s[58:59]
    v_pk_fma_f32 v[246:247], v[246:247], s[58:59], s[58:59]
    v_pk_fma_f32 v[248:249], v[248:249], s[58:59], s[58:59]
    v_rcp_f32 v242, v242
    v_rcp_f32 v243, v243
    v_rcp_f32 v244, v244
    v_rcp_f32 v245, v245
    v_rcp_f32 v246, v246
    v_rcp_f32 v247, v247
    v_rcp_f32 v248, v248
    v_rcp_f32 v249, v249
    v_pk_mul_f32 v[242:243], v[132:133], v[242:243]
    v_pk_mul_f32 v[244:245], v[134:135], v[244:245]
    v_pk_mul_f32 v[246:247], v[140:141], v[246:247]
    v_pk_mul_f32 v[248:249], v[142:143], v[248:249]
    v_cvt_pk_bf16_f32 v132, v242, v243
    v_cvt_pk_bf16_f32 v134, v246, v247
    v_cvt_pk_bf16_f32 v133, v244, v245
    v_cvt_pk_bf16_f32 v135, v248, v249
    v_pk_fma_f32 v[128:129], v[128:129], v[20:21], v[28:29]
    v_pk_fma_f32 v[130:131], v[130:131], v[22:23], v[30:31]
    v_pk_fma_f32 v[136:137], v[136:137], v[88:89], v[84:85]
    v_pk_fma_f32 v[138:139], v[138:139], v[90:91], v[86:87]
    v_permlane16_swap_b32 v132, v134
    v_permlane16_swap_b32 v133, v135
    buffer_store_dwordx4 v[132:135], v251, s[28:31], s69 offen offset:0 sc1
    v_exp_f32_e64 v242, -v128
    v_exp_f32_e64 v243, -v129
    v_exp_f32_e64 v244, -v130
    v_exp_f32_e64 v245, -v131
    v_exp_f32_e64 v246, -v136
    v_exp_f32_e64 v247, -v137
    v_exp_f32_e64 v248, -v138
    v_exp_f32_e64 v249, -v139
    v_pk_fma_f32 v[242:243], v[242:243], s[58:59], s[58:59]
    v_pk_fma_f32 v[244:245], v[244:245], s[58:59], s[58:59]
    v_pk_fma_f32 v[246:247], v[246:247], s[58:59], s[58:59]
    v_pk_fma_f32 v[248:249], v[248:249], s[58:59], s[58:59]
    v_rcp_f32 v242, v242
    v_rcp_f32 v243, v243
    v_rcp_f32 v244, v244
    v_rcp_f32 v245, v245
    v_rcp_f32 v246, v246
    v_rcp_f32 v247, v247
    v_rcp_f32 v248, v248
    v_rcp_f32 v249, v249
    v_pk_mul_f32 v[242:243], v[128:129], v[242:243]
    v_pk_mul_f32 v[244:245], v[130:131], v[244:245]
    v_pk_mul_f32 v[246:247], v[136:137], v[246:247]
    v_pk_mul_f32 v[248:249], v[138:139], v[248:249]
    v_cvt_pk_bf16_f32 v128, v242, v243
    v_cvt_pk_bf16_f32 v130, v246, v247
    v_cvt_pk_bf16_f32 v129, v244, v245
    v_cvt_pk_bf16_f32 v131, v248, v249
N_11:
    s_cbranch_execz L_tret
    v_permlane16_swap_b32 v128, v130
    v_permlane16_swap_b32 v129, v131
    buffer_store_dwordx4 v[128:131], v251, s[28:31], s68 offen offset:0 sc1
L_last:
    s_endpgm
.section .rodata,"a"
.p2align 6
.amdhsa_kernel standalone__batchnorm__sampling_kernel
  .amdhsa_next_free_vgpr 256
  .amdhsa_next_free_sgpr 102
  .amdhsa_accum_offset 256
  .amdhsa_group_segment_fixed_size 0
  .amdhsa_kernarg_size 72
  .amdhsa_user_sgpr_count 2
  .amdhsa_user_sgpr_kernarg_segment_ptr 1
  .amdhsa_system_sgpr_workgroup_id_x 1
  .amdhsa_float_denorm_mode_32 3
.end_amdhsa_kernel
```
